```python
import torch

def _softmax(x, axis=-1):
    return torch.softmax(x, dim=axis)
def _gelu(x):
    return torch.nn.functional.gelu(x, approximate="tanh")
def _silu(x):
    return torch.nn.functional.silu(x)
def _sigmoid(x):
    return torch.sigmoid(x)
def _layernorm(x, axis=-1, eps=1e-5):
    m = x.mean(dim=axis, keepdim=True)
    v = x.var(dim=axis, keepdim=True, unbiased=False)
    return (x - m) / torch.sqrt(v + eps)
def _scatter_add(tgt, idx, src, axis=0):
    return tgt.clone().index_add_(axis, idx, src)
def _segment_sum(src, seg, n):
    out = torch.zeros((n,) + src.shape[1:], dtype=src.dtype)
    return out.index_add_(0, seg, src)
def _pad(x, pw):
    flat = tuple(v for pair in reversed(pw) for v in pair)
    return torch.nn.functional.pad(x, flat)

kernel_name = 'concat_heads__spectral_fnet__sliding_local_dilated__prompt'

def setup_inputs():

    _w = (lambda a: (lambda t: t.to(torch.bfloat16) if t.is_floating_point() else t)(torch.as_tensor(a)))
    def _A_setup():
        B, S, D = 1, 2048, 576
        ns = torch.arange(S)[:, None] * torch.arange(S)[None, :]
        nd = torch.arange(D)[:, None] * torch.arange(D)[None, :]
        Ws_re = torch.cos(-2.0 * torch.pi * ns / S).to(float)
        Ws_im = torch.sin(-2.0 * torch.pi * ns / S).to(float)
        Wd_re = torch.cos(-2.0 * torch.pi * nd / D).to(float)
        Wd_im = torch.sin(-2.0 * torch.pi * nd / D).to(float)
        return {
            "x": _w((lambda *s: torch.randn(*s, dtype=torch.bfloat16) * 0.05)(B, S, D)),
            "dft_seq_re": _w(Ws_re),
            "dft_seq_im": _w(Ws_im),
            "dft_hid_re": _w(Wd_re),
            "dft_hid_im": _w(Wd_im),
        }
    _A_in = _A_setup()

    def _B_setup():
        B, S, D = 1, 2048, 576
        return {
            "x": _w((lambda *s: torch.randn(*s, dtype=torch.bfloat16) * 0.2)(B, S, D)),
            "wqkv": _w((lambda *s: torch.randn(*s, dtype=torch.bfloat16) * 0.8)(D, 3 * D)),
            "wo": _w((lambda *s: torch.randn(*s, dtype=torch.bfloat16) * 0.2)(D, D)),
        }
    _B_in = _B_setup()

    return {
        "A_x": _A_in["x"],
        "A_dft_seq_re": _A_in["dft_seq_re"],
        "A_dft_seq_im": _A_in["dft_seq_im"],
        "A_dft_hid_re": _A_in["dft_hid_re"],
        "A_dft_hid_im": _A_in["dft_hid_im"],
        "B_x": _B_in["x"],
        "B_wqkv": _B_in["wqkv"],
        "B_wo": _B_in["wo"],
    }

def reference(A_x, A_dft_seq_re, A_dft_seq_im, A_dft_hid_re, A_dft_hid_im, B_x, B_wqkv, B_wo):
    def _A_ref(x, dft_seq_re, dft_seq_im, dft_hid_re, dft_hid_im):
        a = torch.einsum("bsd,ed->bse", x, dft_hid_re)
        b = torch.einsum("bsd,ed->bse", x, dft_hid_im)
        y = torch.einsum("ts,bse->bte", dft_seq_re, a) - torch.einsum("ts,bse->bte", dft_seq_im, b)
        return y

    def _B_ref(x, wqkv, wo):
        B, S, D = x.shape
        H = 32; Dh = D // H
        W, dil = 8, 2
        qkv = (lambda x, *d: x.permute(*d))((x @ wqkv).reshape(B, S, 3, H, Dh), 2, 0, 3, 1, 4)
        q, k, v = qkv[0], qkv[1], qkv[2]
        scale = Dh ** -0.5
        pos = torch.arange(S)
        off = torch.arange(W) * dil
        idx = pos[:, None] - off[None, :]
        mask = idx >= 0
        idx_c = torch.where(mask, idx, 0).reshape(-1)
        kg = k[:, :, idx_c, :].reshape(B, H, S, W, Dh)
        vg = v[:, :, idx_c, :].reshape(B, H, S, W, Dh)
        logits = torch.einsum("bhsd,bhswd->bhsw", q, kg) * scale
        logits = torch.where(mask[None, None, :, :], logits, -1e9)
        attn = _softmax(logits, axis=-1)
        o = torch.einsum("bhsw,bhswd->bhsd", attn, vg)
        return (lambda x, *d: x.permute(*d))(o, 0, 2, 1, 3).reshape(B, S, D) @ wo

    a = _A_ref(A_x, A_dft_seq_re, A_dft_seq_im, A_dft_hid_re, A_dft_hid_im)
    b = _B_ref(B_x, B_wqkv, B_wo)
    return torch.concatenate([a, b], axis=-1)
```

```asm
; @launch grid=(256,1,1) block=(512,1,1) lds=154240
.amdgcn_target "amdgcn-amd-amdhsa--gfx950"
.text
.globl concat_heads__spectral_fnet__sliding_local_dilated__prompt_kernel
.p2align 8
.type concat_heads__spectral_fnet__sliding_local_dilated__prompt_kernel,@function
concat_heads__spectral_fnet__sliding_local_dilated__prompt_kernel:
L_top:
    s_cmpk_ge_u32 s2, 256
    s_cbranch_scc1 L_end
    s_cmpk_lt_u32 s2, 240
    s_cbranch_scc1 L_e1
    s_getpc_b64 s[36:37]
L_e0:
    v_lshlrev_b32 v250, 7, v0
    v_min_u32 v250, L_last-L_e0, v250
    global_load_dword v251, v250, s[36:37]
L_e1:
    s_load_dwordx2 s[8:9], s[0:1], 40
    s_load_dwordx2 s[12:13], s[0:1], 48
    s_load_dwordx2 s[4:5], s[0:1], 0

    s_load_dwordx2 s[16:17], s[0:1], 56
    s_load_dwordx2 s[20:21], s[0:1], 64
    s_load_dwordx2 s[28:29], s[0:1], 72
    s_load_dwordx2 s[24:25], s[0:1], 80
    v_lshrrev_b32 v1, 6, v0
    v_and_b32 v0, 63, v0
    v_readfirstlane_b32 s3, v1
    s_mov_b32 s10, 2359296
    s_mov_b32 s11, 0x20000
    s_mov_b32 s14, 1990656
    s_mov_b32 s15, s11
    s_mov_b32 s18, 663552
    s_mov_b32 s19, s11
    s_mov_b32 s22, 4718592
    s_mov_b32 s23, s11
    s_mov_b32 s26, 0x10000000
    s_mov_b32 s27, s11
    s_movk_i32 s30, 256
    s_mov_b32 s31, s11
    s_and_b32 s32, s2, 7
    s_lshl_b32 s32, s32, 1
    s_lshr_b32 s33, s2, 3
    s_cmp_ge_u32 s33, 18
    s_cbranch_scc1 L_A
    s_cmp_ge_u32 s33, 9
    s_cselect_b32 s6, 9, 0
    s_addc_u32 s32, s32, 0
    s_sub_u32 s33, s33, s6
    s_xor_b32 s3, s3, 4
    s_cmp_lt_u32 s3, 4
    s_cbranch_scc1 L_Bc
    s_setprio 3
    s_sub_u32 s39, s3, 4
    v_and_b32 v1, 7, v0
    v_lshlrev_b32 v1, 4, v1
    v_bfe_u32 v2, v0, 3, 1
    v_bfe_u32 v3, v0, 4, 1
    v_lshrrev_b32 v4, 5, v0
    s_lshl_b32 s6, s39, 1
    v_lshl_add_u32 v5, v3, 3, v2
    v_add_u32 v5, s6, v5
    v_lshl_add_u32 v83, v4, 4, v5
    v_mul_u32_u24 v80, 2304, v83
    v_add_u32 v80, v80, v1
    v_lshl_add_u32 v6, v3, 2, v2
    v_lshl_add_u32 v6, v4, 4, v6
    s_and_b32 s34, s39, 1
    s_lshl_b32 s34, s34, 1
    s_lshr_b32 s35, s39, 1
    s_lshl_b32 s35, s35, 3
    s_add_u32 s34, s34, s35
    v_add_u32 v6, s34, v6
    v_mul_u32_u24 v82, 3456, v6
    s_lshl_b32 s35, s33, 7
    v_add3_u32 v82, v82, v1, s35
    v_add_u32 v6, s6, v2
    v_lshl_add_u32 v6, v6, 1, v3
    s_lshl_b32 s34, s32, 7
    s_sub_u32 s34, s34, 16
    s_max_i32 s34, s34, 0
    v_add_u32 v6, s34, v6
    v_mul_u32_u24 v81, 1152, v6
    v_add_u32 v81, v81, v1
    s_mul_i32 s63, s32, 147456

    s_mul_i32 s34, s32, 0
    s_mul_i32 s6, s33, 0
    s_add_u32 s34, s34, s6
    s_mul_i32 s6, s34, 57
    s_lshr_b32 s6, s6, 9
    s_mul_i32 s6, s6, 9
    s_sub_u32 s34, s34, s6
    s_lshl_b32 s67, s34, 7
    s_add_u32 s68, s63, s67
    s_mul_i32 s69, s67, 1728
    s_mul_i32 s64, s39, 1056
    s_mul_i32 s65, s39, 544
    s_mov_b32 s66, 0
    s_waitcnt lgkmcnt(0)
L_ld:
    s_add_u32 m0, s64, 0
    s_add_u32 s7, s68, 0
    buffer_load_dwordx4 v80, s[8:11], s7 offen  lds
    s_add_u32 m0, s64, 4224
    s_add_u32 s7, s68, 1152
    buffer_load_dwordx4 v80, s[8:11], s7 offen  lds
    s_add_u32 m0, s64, 8448
    s_add_u32 s7, s68, 73728
    buffer_load_dwordx4 v80, s[8:11], s7 offen  lds
    s_add_u32 m0, s64, 12672
    s_add_u32 s7, s68, 74880
    buffer_load_dwordx4 v80, s[8:11], s7 offen  lds
    s_add_u32 m0, s65, 25344
    s_mov_b32 exec_hi, 0
    buffer_load_dwordx4 v81, s[8:11], s67 offen lds
    s_mov_b32 exec_hi, -1
    s_add_u32 m0, s64, 27520
    s_add_u32 s7, s69, 0
    buffer_load_dwordx4 v82, s[12:15], s7 offen  lds
    s_add_u32 m0, s64, 31744
    s_add_u32 s7, s69, 1152
    buffer_load_dwordx4 v82, s[12:15], s7 offen  lds
    s_add_u32 m0, s64, 16896
    s_add_u32 s7, s69, 2304
    buffer_load_dwordx4 v82, s[12:15], s7 offen  lds
    s_add_u32 m0, s64, 35968
    s_add_u32 s7, s69, 110592
    buffer_load_dwordx4 v82, s[12:15], s7 offen  lds
    s_add_u32 m0, s64, 40192
    s_add_u32 s7, s69, 111744
    buffer_load_dwordx4 v82, s[12:15], s7 offen  lds
    s_add_u32 m0, s64, 21120
    s_add_u32 s7, s69, 112896
    buffer_load_dwordx4 v82, s[12:15], s7 offen  lds
    s_add_u32 s67, s67, 128
    s_cmp_eq_u32 s67, 1152
    s_cselect_b32 s67, 0, s67
    s_add_u32 s68, s63, s67
    s_mul_i32 s69, s67, 1728
    s_add_u32 s64, s64, 44416
    s_add_u32 s65, s65, 44416
    s_cmp_ge_u32 s64, 133248
    s_cselect_b32 s6, 133248, 0
    s_sub_u32 s64, s64, s6
    s_sub_u32 s65, s65, s6
    s_add_u32 s66, s66, 1
    s_cmp_lt_u32 s66, 2
    s_cbranch_scc1 L_ldb
    s_waitcnt vmcnt(11)
L_ldb:
    s_barrier
    s_cmp_lt_u32 s66, 9
    s_cbranch_scc1 L_ld
    v_lshl_add_u32 v84, v4, 5, v83
    v_add_u32 v83, 16, v83
    v_mul_u32_u24 v83, 1152, v83
    v_mul_u32_u24 v84, 1152, v84
    v_add3_u32 v83, v83, v1, s35
    v_add3_u32 v84, v84, v1, s35
    s_add_u32 s69, s33, 4
    s_cmp_ge_u32 s69, 9
    s_cselect_b32 s6, 9, 0
    s_sub_u32 s69, s69, s6
    s_mul_i32 s69, s69, 73728
    s_add_u32 m0, s64, 137344
    s_add_u32 s69, s69, 73728
    s_cmp_eq_u32 s69, s18
    s_cselect_b32 s69, 0, s69
    buffer_load_dwordx4 v83, s[16:19], s69 offen lds
    s_add_u32 m0, s64, 141568
    s_add_u32 s69, s69, 73728
    s_cmp_eq_u32 s69, s18
    s_cselect_b32 s69, 0, s69
    buffer_load_dwordx4 v83, s[16:19], s69 offen lds
    s_add_u32 m0, s64, 145792
    s_add_u32 s69, s69, 73728
    s_cmp_eq_u32 s69, s18
    s_cselect_b32 s69, 0, s69
    buffer_load_dwordx4 v83, s[16:19], s69 offen lds
    s_add_u32 m0, s64, 150016
    s_add_u32 s69, s69, 73728
    s_cmp_eq_u32 s69, s18
    s_cselect_b32 s69, 0, s69
    buffer_load_dwordx4 v83, s[16:19], s69 offen lds
    s_setprio 1
    s_branch L_const0
L_cretA:
    s_waitcnt vmcnt(4)
    s_add_u32 s66, s66, 1
    s_barrier
    s_mul_i32 s67, s32, 768
    s_add_u32 s67, s67, 12582912
    s_cmp_lg_u32 s3, 4
    s_cbranch_scc1 L_Bn0
    s_mov_b64 exec, 0x3f
    buffer_load_dword v249, off, s[28:31], 0 sc1
    buffer_load_dword v87, v200, s[24:27], s67 offen sc1
    s_mov_b64 exec, -1
L_Bn0:
    s_mul_i32 s34, s33, 73728
    v_add_u32 v85, s64, v248
    buffer_load_dwordx4 v[48:51], v84, s[16:19], s34 offen
    s_add_u32 s34, s34, 73728
    s_cmp_eq_u32 s34, s18
    s_cselect_b32 s34, 0, s34
    buffer_load_dwordx4 v[52:55], v84, s[16:19], s34 offen
    s_add_u32 s34, s34, 73728
    s_cmp_eq_u32 s34, s18
    s_cselect_b32 s34, 0, s34
    buffer_load_dwordx4 v[56:59], v84, s[16:19], s34 offen
    s_branch L_const1
L_cretB:
    s_movk_i32 s5, 3750
    s_waitcnt vmcnt(9)
    s_cmp_lg_u32 s3, 4
    s_cbranch_scc1 L_Bnd
    s_mov_b64 exec, 0x3f
L_Bn:
    v_cmp_ne_u32 vcc, v87, v249
    v_cmp_le_i32 s[6:7], 0, v249
    s_or_b64 vcc, vcc, s[6:7]
    s_cbranch_scc0 L_Bnd
    s_sleep 8
    s_mov_b64 exec, 0x3f
    buffer_load_dword v249, off, s[28:31], 0 sc1
    buffer_load_dword v87, v200, s[24:27], s67 offen sc1
    s_sub_u32 s5, s5, 1
    s_waitcnt vmcnt(0)
    s_cbranch_scc0 L_Bn
L_Bnd:
    s_mov_b64 exec, -1
    s_setprio 1
    s_barrier
    ds_read2st64_b64 v[88:91], v202 offset0:0 offset1:1
    ds_read2st64_b64 v[92:95], v202 offset0:2 offset1:3
    ds_read2st64_b64 v[96:99], v201 offset0:0 offset1:1
    ds_read2st64_b64 v[100:103], v201 offset0:2 offset1:3
    ds_read2st64_b64 v[104:107], v204 offset0:0 offset1:1
    ds_read2st64_b64 v[108:111], v204 offset0:2 offset1:3
    s_add_u32 m0, s64, 88832
    s_add_u32 s69, s69, 73728
    s_cmp_eq_u32 s69, s18
    s_cselect_b32 s69, 0, s69
    buffer_load_dwordx4 v83, s[16:19], s69 offen lds
    s_waitcnt lgkmcnt(5)
    v_cndmask_b32 v112, 0, v88, s[40:41]
    v_cndmask_b32 v113, 0, v89, s[42:43]
    s_waitcnt lgkmcnt(4)
    v_cndmask_b32 v126, v94, 0, s[52:53]
    v_cndmask_b32 v127, v95, 0, s[54:55]
    s_waitcnt lgkmcnt(3)
    v_mfma_f32_16x16x16_bf16 v[128:131], v[96:97], v[112:113], v[192:195]
    s_add_u32 m0, s64, 93056
    s_add_u32 s69, s69, 73728
    s_cmp_eq_u32 s69, s18
    s_cselect_b32 s69, 0, s69
    buffer_load_dwordx4 v83, s[16:19], s69 offen lds
    s_waitcnt lgkmcnt(2)
    v_mfma_f32_16x16x16_bf16 v[132:135], v[102:103], v[126:127], v[192:195]
    s_waitcnt lgkmcnt(1)
    v_mfma_f32_16x16x16_bf16 v[148:151], v[104:105], v[112:113], v[192:195]
    s_waitcnt lgkmcnt(0)
    v_mfma_f32_16x16x16_bf16 v[152:155], v[110:111], v[126:127], v[192:195]
    v_cndmask_b32 v114, v88, 0, s[40:41]
    v_cndmask_b32 v115, v89, 0, s[42:43]
    s_add_u32 m0, s64, 97280
    s_add_u32 s69, s69, 73728
    s_cmp_eq_u32 s69, s18
    s_cselect_b32 s69, 0, s69
    buffer_load_dwordx4 v83, s[16:19], s69 offen lds
    v_cndmask_b32 v116, 0, v90, s[44:45]
    v_cndmask_b32 v117, 0, v91, s[46:47]
    v_cndmask_b32 v118, v90, 0, s[44:45]
    v_cndmask_b32 v119, v91, 0, s[46:47]
    s_mov_b64 exec, s[100:101]
    v_mov_b64 v[128:129], v[148:149]
    v_mov_b64 v[130:131], v[150:151]
    v_mov_b64 v[132:133], v[152:153]
    v_mov_b64 v[134:135], v[154:155]
    s_mov_b64 exec, -1
    s_add_u32 m0, s64, 101504
    s_add_u32 s69, s69, 73728
    s_cmp_eq_u32 s69, s18
    s_cselect_b32 s69, 0, s69
    buffer_load_dwordx4 v83, s[16:19], s69 offen lds
    v_min_u32 v128, -2, v128
    buffer_store_dwordx4 v[128:131], v248, s[24:27], s76 offen sc1
    v_min_u32 v132, -2, v132
    buffer_store_dwordx4 v[132:135], v248, s[24:27], s77 offen sc1
    v_cndmask_b32 v120, 0, v92, s[48:49]
    s_add_u32 m0, s64, 105728
    s_add_u32 s69, s69, 73728
    s_cmp_eq_u32 s69, s18
    s_cselect_b32 s69, 0, s69
    buffer_load_dwordx4 v83, s[16:19], s69 offen lds
    v_cndmask_b32 v121, 0, v93, s[50:51]
    v_cndmask_b32 v122, v92, 0, s[48:49]
    v_cndmask_b32 v123, v93, 0, s[50:51]
    v_cndmask_b32 v124, 0, v94, s[52:53]
    v_cndmask_b32 v125, 0, v95, s[54:55]
    s_cmp_lg_u32 s3, 4
    s_cbranch_scc1 L_Bv0
    s_add_u32 s67, s67, 16384
    s_mov_b64 exec, 0x3f
    buffer_load_dword v87, v200, s[24:27], s67 offen sc1
    s_mov_b64 exec, -1
L_Bv0:
    s_mul_i32 s69, s33, 73728
    s_branch L_BF
L_Bc:
    v_bfe_u32 v6, v0, 1, 2
    v_and_b32 v7, 1, v0
    v_bfe_u32 v4, v0, 3, 1
    v_lshl_add_u32 v7, v4, 1, v7
    v_and_b32 v4, 0x30, v0
    v_lshl_add_u32 v7, v7, 7, v4
    s_and_b32 s6, s3, 1
    s_mul_i32 s6, s6, 4224
    v_mul_u32_u24 v2, 1056, v6
    v_add3_u32 v2, v2, v7, s6
    v_mul_u32_u24 v3, 544, v6
    v_add_u32 v3, v3, v7
    v_add_u32 v3, 25344, v3
    v_mov_b32 v6, v2
    v_mov_b32 v7, v3
    v_mov_b32 v8, 0
    v_mov_b32 v9, 0
    v_mov_b32 v10, 0
    v_mov_b32 v11, 0
    v_mov_b32 v12, 0
    v_mov_b32 v13, 0
    v_mov_b32 v14, 0
    v_mov_b32 v15, 0
    v_mov_b32 v16, 0
    v_mov_b32 v17, 0
    v_mov_b32 v18, 0
    v_mov_b32 v19, 0
    v_mov_b32 v20, 0
    v_mov_b32 v21, 0
    v_mov_b32 v22, 0
    v_mov_b32 v23, 0
    v_mov_b32 v24, 0
    v_mov_b32 v25, 0
    v_mov_b32 v26, 0
    v_mov_b32 v27, 0
    v_mov_b32 v28, 0
    v_mov_b32 v29, 0
    v_mov_b32 v30, 0
    v_mov_b32 v31, 0
    v_mov_b32 v32, 0
    v_mov_b32 v33, 0
    v_mov_b32 v34, 0
    v_mov_b32 v35, 0
    v_mov_b32 v36, 0
    v_mov_b32 v37, 0
    v_mov_b32 v38, 0
    v_mov_b32 v39, 0
    v_mov_b32 v40, 0
    v_mov_b32 v41, 0
    v_mov_b32 v42, 0
    v_mov_b32 v43, 0
    v_mov_b32 v88, 0
    v_mov_b32 v89, 0
    v_mov_b32 v90, 0
    v_mov_b32 v91, 0
    v_mov_b32 v92, 0
    v_mov_b32 v93, 0
    v_mov_b32 v94, 0
    v_mov_b32 v95, 0
    v_mov_b32 v96, 0
    v_mov_b32 v97, 0
    v_mov_b32 v98, 0
    v_mov_b32 v99, 0
    v_mov_b32 v100, 0
    v_mov_b32 v101, 0
    v_mov_b32 v102, 0
    v_mov_b32 v103, 0
    v_mov_b32 v104, 0
    v_mov_b32 v105, 0
    v_mov_b32 v106, 0
    v_mov_b32 v107, 0
    v_mov_b32 v108, 0
    v_mov_b32 v109, 0
    v_mov_b32 v110, 0
    v_mov_b32 v111, 0
    v_mov_b32 v112, 0
    v_mov_b32 v113, 0
    v_mov_b32 v114, 0
    v_mov_b32 v115, 0
    v_mov_b32 v116, 0
    v_mov_b32 v117, 0
    v_mov_b32 v118, 0
    v_mov_b32 v119, 0
    v_mov_b32 v120, 0
    v_mov_b32 v121, 0
    v_mov_b32 v122, 0
    v_mov_b32 v123, 0
    v_mov_b32 v124, 0
    v_mov_b32 v125, 0
    v_mov_b32 v126, 0
    v_mov_b32 v127, 0
    v_mov_b32 v128, 0
    v_mov_b32 v129, 0
    v_mov_b32 v130, 0
    v_mov_b32 v131, 0
    v_mov_b32 v132, 0
    v_mov_b32 v133, 0
    v_mov_b32 v134, 0
    v_mov_b32 v135, 0
    v_mov_b32 v136, 0
    v_mov_b32 v137, 0
    v_mov_b32 v138, 0
    v_mov_b32 v139, 0
    v_mov_b32 v140, 0
    v_mov_b32 v141, 0
    v_mov_b32 v142, 0
    v_mov_b32 v143, 0
    v_mov_b32 v144, 0
    v_mov_b32 v145, 0
    v_mov_b32 v146, 0
    v_mov_b32 v147, 0
    v_mov_b32 v148, 0
    v_mov_b32 v149, 0
    v_mov_b32 v150, 0
    v_mov_b32 v151, 0
    v_mov_b32 v152, 0
    v_mov_b32 v153, 0
    v_mov_b32 v154, 0
    v_mov_b32 v155, 0
    v_mov_b32 v83, 0
    v_mov_b32 v84, 0
    s_mov_b32 s34, 0
    s_memrealtime s[6:7]
    s_or_b32 s35, s2, s3
    s_waitcnt lgkmcnt(0)
    s_cbranch_scc1 L_Bc2
    s_or_b32 s6, s6, 0x80000000
    v_mov_b32 v1, s6
    s_mov_b64 exec, 1
    buffer_store_dword v1, off, s[28:31], 0 sc1
    s_mov_b64 exec, -1
L_Bc2:
    s_barrier
L_const0:
    v_and_b32 v216, 15, v0
    v_lshrrev_b32 v217, 4, v0
    v_lshlrev_b32 v218, 2, v217
    v_and_b32 v219, 7, v0
    v_sub_u32 v219, v218, v219
    v_lshlrev_b32 v248, 4, v0
    v_lshlrev_b32 v255, 3, v0
    v_lshlrev_b32 v200, 7, v0
    s_mov_b32 s100, 0x00ff00ff
    s_mov_b32 s101, s100
    s_lshr_b32 s6, s3, 1
    s_or_b32 s6, s6, s32
    s_cmp_eq_u32 s6, 0
    s_cselect_b32 exec_lo, s100, 0
    s_mov_b32 exec_hi, 0
    v_mov_b32 v219, 64
    s_mov_b64 exec, -1
    v_mov_b32 v220, 0xf149f2ca
    v_add_u32 v221, -1, v219
    v_cmp_le_u32 vcc, 8, v221
    s_nop 1
    v_cndmask_b32 v192, 0, v220, vcc
    v_add_u32 v221, 0, v219
    v_cmp_le_u32 vcc, 8, v221
    s_nop 1
    v_cndmask_b32 v193, 0, v220, vcc
    v_add_u32 v221, 1, v219
    v_cmp_le_u32 vcc, 8, v221
    s_nop 1
    v_cndmask_b32 v194, 0, v220, vcc
    v_add_u32 v221, 2, v219
    v_cmp_le_u32 vcc, 8, v221
    s_nop 1
    v_cndmask_b32 v195, 0, v220, vcc
    s_cmp_ge_u32 s3, 4
    s_cbranch_scc1 L_cretA
L_const1:
    s_lshl_b32 s6, s33, 6
    s_add_u32 s7, s6, 17
    s_mul_i32 s7, s7, 3641
    s_lshr_b32 s7, s7, 16
    s_mul_i32 s7, s7, 18
    s_sub_u32 s6, s7, s6
    s_mov_b32 s7, s6
    s_sub_u32 s4, s7, 2
    v_cmp_gt_i32 s[40:41], s7, v218
    v_cmp_gt_i32 s[42:43], s4, v218
    s_cmp_eq_u32 s6, 16
    s_cselect_b32 s4, -16, 2
    s_add_u32 s7, s7, s4
    s_sub_u32 s4, s7, 2
    v_cmp_gt_i32 s[44:45], s7, v218
    v_cmp_gt_i32 s[46:47], s4, v218
    s_cmp_eq_u32 s6, 14
    s_cselect_b32 s4, -16, 2
    s_add_u32 s7, s7, s4
    s_sub_u32 s4, s7, 2
    v_cmp_gt_i32 s[48:49], s7, v218
    v_cmp_gt_i32 s[50:51], s4, v218
    s_cmp_eq_u32 s6, 12
    s_cselect_b32 s4, -16, 2
    s_add_u32 s7, s7, s4
    s_sub_u32 s4, s7, 2
    v_cmp_gt_i32 s[52:53], s7, v218
    v_cmp_gt_i32 s[54:55], s4, v218
    s_cmp_lt_u32 s3, 4
    s_cbranch_scc1 L_cw1
    s_add_u32 s34, s34, 73728
    s_cmp_eq_u32 s34, s18
    s_cselect_b32 s34, 0, s34
    buffer_load_dwordx4 v[60:63], v84, s[16:19], s34 offen
    s_add_u32 s34, s34, 73728
    s_cmp_eq_u32 s34, s18
    s_cselect_b32 s34, 0, s34
    buffer_load_dwordx4 v[64:67], v84, s[16:19], s34 offen
L_cw1:
    s_and_b32 s70, s3, 3
    s_lshr_b32 s71, s3, 2
    s_lshl_b32 s72, s70, 1
    s_add_u32 s72, s72, s71
    s_lshl_b32 s6, s72, 11
    s_add_u32 s7, s6, 27520
    v_add_u32 v202, s7, v255
    v_add_u32 v201, 44416, v202
    v_add_u32 v203, 88832, v202
    s_cmp_ge_u32 s3, 4
    s_cselect_b32 s4, 1, 3
    s_lshl_b32 s4, s4, 11
    s_sub_u32 s6, s6, s4
    s_add_u32 s4, s6, 72000
    s_add_u32 s5, s6, 116608
    s_lshl_b32 s6, s3, 6
    s_add_u32 s6, s6, 133248
    s_lshl_b32 s7, s3, 8
    s_add_u32 s7, s7, 135296
    s_cmp_lt_u32 s3, 2
    s_cselect_b32 s4, s6, s4
    s_cselect_b32 s5, s7, s5
    v_add_u32 v204, s4, v255
    v_add_u32 v205, s5, v255
    s_not_b64 exec, s[100:101]
    v_subrev_u32 v204, 64, v201
    s_mov_b32 exec_lo, 0
    s_mov_b32 exec_hi, -1
    v_subrev_u32 v205, 0x100, v203
    s_mov_b32 exec_lo, -1
    v_mov_b32 v172, 0
    v_mov_b32 v173, 0
    v_mov_b32 v174, 0
    v_mov_b32 v175, 0
    v_mov_b32 v176, 0
    v_mov_b32 v177, 0
    s_cmp_lt_u32 s3, 4
    s_cbranch_scc1 L_cw2
    s_add_u32 s34, s34, 73728
    s_cmp_eq_u32 s34, s18
    s_cselect_b32 s34, 0, s34
    buffer_load_dwordx4 v[68:71], v84, s[16:19], s34 offen
    s_add_u32 s34, s34, 73728
    s_cmp_eq_u32 s34, s18
    s_cselect_b32 s34, 0, s34
    buffer_load_dwordx4 v[72:75], v84, s[16:19], s34 offen
L_cw2:
    s_lshr_b32 s4, s70, 1
    s_and_b32 s6, s70, 1
    s_lshl_b32 s4, s4, 6
    s_add_u32 s4, s4, s6
    s_lshl_b32 s5, s71, 5
    s_add_u32 s4, s4, s5
    s_lshl_b32 s5, s32, 7
    s_add_u32 s4, s4, s5
    s_mul_i32 s4, s4, 2304
    s_lshl_b32 s5, s33, 7
    s_add_u32 s4, s4, s5
    s_add_u32 s73, s4, 1152
    v_lshrrev_b32 v221, 3, v0
    v_and_b32 v222, 0x70, v248
    v_mov_b32 v223, 4608
    v_mad_u32_u24 v254, v221, v223, v222
    s_lshl_b32 s4, s70, 12
    s_mul_i32 s5, s71, 44416
    s_sub_u32 s4, s4, s5
    s_add_u32 s4, s4, 71936
    v_mul_u32_u24 v253, 144, v221
    v_add3_u32 v253, v253, v222, s4
    v_mul_u32_u24 v252, 144, v216
    v_lshl_add_u32 v252, v217, 3, v252
    v_add_u32 v252, s4, v252
    v_bfe_u32 v221, v0, 3, 2
    v_mul_u32_u24 v221, 1056, v221
    v_bfe_u32 v222, v0, 2, 1
    v_lshl_add_u32 v221, v222, 7, v221
    v_and_b32 v222, 3, v0
    v_lshl_add_u32 v207, v222, 3, v221
    v_lshrrev_b32 v222, 5, v0
    v_lshl_add_u32 v250, v222, 8, v207
    s_mul_i32 s4, s71, 92928
    s_add_u32 s4, s4, 44416
    s_mul_i32 s5, s71, 88832
    v_add_u32 v251, s4, v250
    v_add_u32 v250, s5, v250
    v_lshl_add_u32 v207, v222, 9, v207
    s_cmp_lt_u32 s3, 4
    s_cbranch_scc1 L_cw3
    s_add_u32 s34, s34, 73728
    s_cmp_eq_u32 s34, s18
    s_cselect_b32 s34, 0, s34
    buffer_load_dwordx4 v[76:79], v84, s[16:19], s34 offen
    s_add_u32 s34, s34, 73728
    s_cmp_eq_u32 s34, s18
    s_cselect_b32 s34, 0, s34
    buffer_load_dwordx4 v[4:7], v84, s[16:19], s34 offen
L_cw3:
    s_lshl_b32 s4, s32, 2
    s_add_u32 s4, s4, s70
    s_mul_i32 s4, s4, 36864
    s_add_u32 s4, s4, 4212736
    s_mul_i32 s6, s71, 18432
    s_sub_u32 s4, s4, s6
    s_lshl_b32 s5, s33, 10
    s_add_u32 s56, s4, s5
    s_mul_i32 s6, s71, 27648
    s_add_u32 s74, s56, s6
    s_sub_u32 s74, s74, 18432
    s_add_u32 s12, s24, 9216
    s_addc_u32 s13, s25, 0
    s_sub_u32 s14, s26, 9216
    s_add_u32 s5, s4, 9216
    s_add_u32 s57, s56, 1024
    v_mov_b32 v178, 0
    s_cmp_eq_u32 s57, s5
    s_cselect_b32 s57, s4, s57
    s_add_u32 s58, s57, 1024
    v_mov_b32 v179, 0
    s_cmp_eq_u32 s58, s5
    s_cselect_b32 s58, s4, s58
    s_add_u32 s59, s58, 1024
    v_mov_b32 v180, 0
    s_cmp_eq_u32 s59, s5
    s_cselect_b32 s59, s4, s59
    s_add_u32 s60, s59, 1024
    v_mov_b32 v181, 0
    s_cmp_eq_u32 s60, s5
    s_cselect_b32 s60, s4, s60
    s_add_u32 s61, s60, 1024
    v_mov_b32 v182, 0
    s_cmp_eq_u32 s61, s5
    s_cselect_b32 s61, s4, s61
    s_add_u32 s62, s61, 1024
    v_mov_b32 v183, 0
    s_cmp_eq_u32 s62, s5
    s_cselect_b32 s62, s4, s62
    s_add_u32 s63, s62, 1024
    v_mov_b32 v184, 0
    s_cmp_eq_u32 s63, s5
    s_cselect_b32 s63, s4, s63
    s_add_u32 s75, s63, 1024
    v_mov_b32 v185, 0
    s_cmp_eq_u32 s75, s5
    s_cselect_b32 s75, s4, s75
    s_mul_i32 s4, s32, 9
    s_add_u32 s4, s4, s33
    s_lshl_b32 s4, s4, 14
    s_lshl_b32 s5, s72, 10
    s_add_u32 s4, s4, s5
    s_add_u32 s76, s4, 8388608
    s_add_u32 s77, s76, 8192
    s_cmp_eq_u32 s33, 0
    s_cselect_b32 s4, 0, 8192
    s_sub_u32 s78, s76, s4
    s_cmp_eq_u32 s33, 8
    s_cselect_b32 s4, 0, 8192
    s_add_u32 s79, s77, s4
    s_lshl_b32 s4, s70, 12
    s_mul_i32 s5, s71, 44416
    s_add_u32 s71, s4, s5
    s_add_u32 s71, s71, 27520
    s_sub_u32 s72, s4, s5
    s_add_u32 s72, s72, 71936
    s_mul_i32 s4, s70, 3072
    s_add_u32 s4, s4, 6400
    s_sub_u32 s68, s71, s4
    s_sub_u32 s65, s72, s4
    s_mov_b32 s70, 0x3eae1a93
    v_mov_b32 v186, 0
    v_mov_b32 v187, 0
    v_mov_b32 v188, 0
    v_mov_b32 v189, 0
    v_mov_b32 v190, 0
    v_mov_b32 v191, 0
    s_cmp_ge_u32 s3, 4
    s_cbranch_scc1 L_cretB
    s_lshl_b32 s6, s3, 5
    v_add_u32 v4, s6, v207
    s_xor_b32 s6, s6, 32
    v_add_u32 v5, s6, v207
    v_add_u32 v210, 16896, v4
    v_add_u32 v211, 16896, v5
    s_and_b32 s6, s3, 1
    s_lshl_b32 s7, s6, 12
    s_add_u32 s7, s7, 27520
    s_lshl_b32 s4, s3, 9
    s_add_u32 s5, s7, s4
    v_add_u32 v84, s5, v255
    s_add_u32 s5, s4, 133248
    v_add_u32 v206, s5, v255
    s_xor_b32 s4, s4, 512
    s_add_u32 s5, s7, s4
    v_add_u32 v85, s5, v255
    v_add_u32 v86, 88832, v84
    v_add_u32 v87, 88832, v85
    s_mov_b32 s36, 0
    s_mov_b32 s37, 4294878464
    s_mov_b32 s35, 0
    s_barrier
    ds_read_b64_tr_b16 v[156:157], v4 offset:27520
    ds_read_b64_tr_b16 v[158:159], v4 offset:27776
    ds_read_b128 v[44:47], v2 offset:0
    ds_read_b128 v[48:51], v2 offset:512
    ds_read_b128 v[52:55], v2 offset:8448
    ds_read_b128 v[56:59], v2 offset:8960
    ds_read_b128 v[60:63], v3 offset:0
    ds_read_b64_tr_b16 v[160:161], v5 offset:27520
    ds_read_b64_tr_b16 v[162:163], v5 offset:27776
    ds_read_b64_tr_b16 v[164:165], v4 offset:31744
    ds_read_b64_tr_b16 v[166:167], v4 offset:32000
    ds_read_b64_tr_b16 v[216:217], v5 offset:16896
    ds_read_b64_tr_b16 v[218:219], v5 offset:17152
    ds_read_b64_tr_b16 v[168:169], v5 offset:31744
    ds_read_b64_tr_b16 v[170:171], v5 offset:32000
    ds_read_b64_tr_b16 v[212:213], v4 offset:16896
    ds_read_b64_tr_b16 v[214:215], v4 offset:17152
    .p2align 3
L_Bl1:
    s_waitcnt lgkmcnt(2)
    v_mfma_f32_16x16x32_bf16 v[88:91], v[156:159], v[44:47], v[88:91]
    s_add_u32 s36, s36, 1
    ds_read_b128 v[64:67], v2 offset:64
    v_mfma_f32_16x16x32_bf16 v[96:99], v[156:159], v[48:51], v[96:99]
    s_cmp_eq_u32 s36, 3
    ds_read_b128 v[68:71], v2 offset:576
    v_mfma_f32_16x16x32_bf16 v[104:107], v[156:159], v[52:55], v[104:107]
    s_cselect_b32 s36, 0, s36
    ds_read_b128 v[72:75], v2 offset:8512
    v_mfma_f32_16x16x32_bf16 v[112:115], v[156:159], v[56:59], v[112:115]
    s_cselect_b32 s38, s37, 44416
    ds_read_b128 v[76:79], v2 offset:9024
    v_mfma_f32_16x16x32_bf16 v[92:95], v[160:163], v[44:47], v[92:95]
    s_add_u32 s35, s35, 1
    ds_read_b128 v[80:83], v3 offset:64
    v_mfma_f32_16x16x32_bf16 v[100:103], v[160:163], v[48:51], v[100:103]
    s_cmp_lt_u32 s35, 6
    ds_read_b64_tr_b16 v[156:157], v4 offset:35968
    v_mfma_f32_16x16x32_bf16 v[108:111], v[160:163], v[52:55], v[108:111]
    ds_read_b64_tr_b16 v[158:159], v4 offset:36224
    v_mfma_f32_16x16x32_bf16 v[116:119], v[160:163], v[56:59], v[116:119]
    ds_read_b64_tr_b16 v[220:221], v5 offset:21120
    v_mfma_f32_16x16x32_bf16 v[120:123], v[164:167], v[44:47], v[120:123]
    ds_read_b64_tr_b16 v[160:161], v5 offset:35968
    v_mfma_f32_16x16x32_bf16 v[128:131], v[164:167], v[48:51], v[128:131]
    ds_read_b64_tr_b16 v[162:163], v5 offset:36224
    v_mfma_f32_16x16x32_bf16 v[136:139], v[164:167], v[52:55], v[136:139]
    ds_read_b64_tr_b16 v[222:223], v5 offset:21376
    v_mfma_f32_16x16x32_bf16 v[144:147], v[164:167], v[56:59], v[144:147]
    v_mfma_f32_16x16x32_bf16 v[152:155], v[164:167], v[60:63], v[152:155]
    v_mfma_f32_16x16x32_bf16 v[124:127], v[168:171], v[44:47], v[124:127]
    ds_read_b64_tr_b16 v[164:165], v4 offset:40192
    v_mfma_f32_16x16x32_bf16 v[132:135], v[168:171], v[48:51], v[132:135]
    ds_read_b64_tr_b16 v[166:167], v4 offset:40448
    v_mfma_f32_16x16x32_bf16 v[140:143], v[168:171], v[52:55], v[140:143]
    v_mfma_f32_16x16x32_bf16 v[148:151], v[168:171], v[56:59], v[148:151]
    s_waitcnt lgkmcnt(2)
    v_mfma_f32_16x16x32_bf16 v[8:11], v[44:47], v[212:215], v[8:11]
    ds_read_b64_tr_b16 v[168:169], v5 offset:40192
    v_mfma_f32_16x16x32_bf16 v[16:19], v[48:51], v[212:215], v[16:19]
    ds_read_b64_tr_b16 v[170:171], v5 offset:40448
    v_mfma_f32_16x16x32_bf16 v[24:27], v[52:55], v[212:215], v[24:27]
    v_mfma_f32_16x16x32_bf16 v[32:35], v[56:59], v[212:215], v[32:35]
    v_mfma_f32_16x16x32_bf16 v[40:43], v[60:63], v[212:215], v[40:43]
    v_mfma_f32_16x16x32_bf16 v[12:15], v[44:47], v[216:219], v[12:15]
    ds_read_b64_tr_b16 v[212:213], v4 offset:21120
    v_mfma_f32_16x16x32_bf16 v[20:23], v[48:51], v[216:219], v[20:23]
    ds_read_b64_tr_b16 v[214:215], v4 offset:21376
    v_mfma_f32_16x16x32_bf16 v[28:31], v[52:55], v[216:219], v[28:31]
    v_mfma_f32_16x16x32_bf16 v[36:39], v[56:59], v[216:219], v[36:39]
    v_mfma_f32_16x16x32_bf16 v[88:91], v[156:159], v[64:67], v[88:91]
    v_add_u32 v4, s38, v4
    v_mfma_f32_16x16x32_bf16 v[96:99], v[156:159], v[68:71], v[96:99]
    v_add_u32 v2, s38, v2
    v_mfma_f32_16x16x32_bf16 v[104:107], v[156:159], v[72:75], v[104:107]
    v_add_u32 v3, s38, v3
    v_mfma_f32_16x16x32_bf16 v[112:115], v[156:159], v[76:79], v[112:115]
    v_add_u32 v5, s38, v5
    s_waitcnt lgkmcnt(0)
    s_barrier
    v_mfma_f32_16x16x32_bf16 v[92:95], v[160:163], v[64:67], v[92:95]
    ds_read_b64_tr_b16 v[156:157], v4 offset:27520
    v_mfma_f32_16x16x32_bf16 v[100:103], v[160:163], v[68:71], v[100:103]
    ds_read_b64_tr_b16 v[158:159], v4 offset:27776
    v_mfma_f32_16x16x32_bf16 v[108:111], v[160:163], v[72:75], v[108:111]
    ds_read_b128 v[44:47], v2 offset:0
    v_mfma_f32_16x16x32_bf16 v[116:119], v[160:163], v[76:79], v[116:119]
    ds_read_b128 v[48:51], v2 offset:512
    v_mfma_f32_16x16x32_bf16 v[120:123], v[164:167], v[64:67], v[120:123]
    ds_read_b128 v[52:55], v2 offset:8448
    v_mfma_f32_16x16x32_bf16 v[128:131], v[164:167], v[68:71], v[128:131]
    ds_read_b128 v[56:59], v2 offset:8960
    v_mfma_f32_16x16x32_bf16 v[136:139], v[164:167], v[72:75], v[136:139]
    ds_read_b128 v[60:63], v3 offset:0
    v_mfma_f32_16x16x32_bf16 v[144:147], v[164:167], v[76:79], v[144:147]
    ds_read_b64_tr_b16 v[160:161], v5 offset:27520
    v_mfma_f32_16x16x32_bf16 v[152:155], v[164:167], v[80:83], v[152:155]
    ds_read_b64_tr_b16 v[162:163], v5 offset:27776
    v_mfma_f32_16x16x32_bf16 v[124:127], v[168:171], v[64:67], v[124:127]
    ds_read_b64_tr_b16 v[164:165], v4 offset:31744
    v_mfma_f32_16x16x32_bf16 v[132:135], v[168:171], v[68:71], v[132:135]
    ds_read_b64_tr_b16 v[166:167], v4 offset:32000
    v_mfma_f32_16x16x32_bf16 v[140:143], v[168:171], v[72:75], v[140:143]
    ds_read_b64_tr_b16 v[216:217], v5 offset:16896
    v_mfma_f32_16x16x32_bf16 v[148:151], v[168:171], v[76:79], v[148:151]
    ds_read_b64_tr_b16 v[218:219], v5 offset:17152
    v_mfma_f32_16x16x32_bf16 v[8:11], v[64:67], v[212:215], v[8:11]
    ds_read_b64_tr_b16 v[168:169], v5 offset:31744
    v_mfma_f32_16x16x32_bf16 v[16:19], v[68:71], v[212:215], v[16:19]
    ds_read_b64_tr_b16 v[170:171], v5 offset:32000
    v_mfma_f32_16x16x32_bf16 v[24:27], v[72:75], v[212:215], v[24:27]
    v_mfma_f32_16x16x32_bf16 v[32:35], v[76:79], v[212:215], v[32:35]
    v_mfma_f32_16x16x32_bf16 v[40:43], v[80:83], v[212:215], v[40:43]
    v_mfma_f32_16x16x32_bf16 v[12:15], v[64:67], v[220:223], v[12:15]
    ds_read_b64_tr_b16 v[212:213], v4 offset:16896
    v_mfma_f32_16x16x32_bf16 v[20:23], v[68:71], v[220:223], v[20:23]
    ds_read_b64_tr_b16 v[214:215], v4 offset:17152
    v_mfma_f32_16x16x32_bf16 v[28:31], v[72:75], v[220:223], v[28:31]
    v_mfma_f32_16x16x32_bf16 v[36:39], v[76:79], v[220:223], v[36:39]
    s_cbranch_scc1 L_Bl1
    .p2align 3
L_Bl2:
    s_waitcnt lgkmcnt(6)
    v_mfma_f32_16x16x32_bf16 v[88:91], v[156:159], v[44:47], v[88:91]
    s_add_u32 s36, s36, 1
    ds_read_b128 v[64:67], v2 offset:64
    v_mfma_f32_16x16x32_bf16 v[96:99], v[156:159], v[48:51], v[96:99]
    s_cmp_eq_u32 s36, 3
    ds_read_b128 v[68:71], v2 offset:576
    v_mfma_f32_16x16x32_bf16 v[104:107], v[156:159], v[52:55], v[104:107]
    s_cselect_b32 s36, 0, s36
    ds_read_b128 v[72:75], v2 offset:8512
    v_mfma_f32_16x16x32_bf16 v[112:115], v[156:159], v[56:59], v[112:115]
    s_cselect_b32 s38, s37, 44416
    ds_read_b128 v[76:79], v2 offset:9024
    s_waitcnt lgkmcnt(6)
    v_mfma_f32_16x16x32_bf16 v[92:95], v[160:163], v[44:47], v[92:95]
    s_add_u32 s35, s35, 1
    ds_read_b128 v[80:83], v3 offset:64
    v_mfma_f32_16x16x32_bf16 v[100:103], v[160:163], v[48:51], v[100:103]
    s_cmp_lt_u32 s35, 8
    ds_read_b64_tr_b16 v[156:157], v4 offset:35968
    v_mfma_f32_16x16x32_bf16 v[108:111], v[160:163], v[52:55], v[108:111]
    ds_read_b64_tr_b16 v[158:159], v4 offset:36224
    v_mfma_f32_16x16x32_bf16 v[116:119], v[160:163], v[56:59], v[116:119]
    ds_read_b64_tr_b16 v[220:221], v5 offset:40192
    v_mfma_f32_16x16x32_bf16 v[120:123], v[164:167], v[44:47], v[120:123]
    ds_read_b64_tr_b16 v[160:161], v5 offset:35968
    v_mfma_f32_16x16x32_bf16 v[128:131], v[164:167], v[48:51], v[128:131]
    ds_read_b64_tr_b16 v[162:163], v5 offset:36224
    v_mfma_f32_16x16x32_bf16 v[136:139], v[164:167], v[52:55], v[136:139]
    ds_read_b64_tr_b16 v[222:223], v5 offset:40448
    v_mfma_f32_16x16x32_bf16 v[144:147], v[164:167], v[56:59], v[144:147]
    v_mfma_f32_16x16x32_bf16 v[152:155], v[164:167], v[60:63], v[152:155]
    s_waitcnt lgkmcnt(4)
    v_mfma_f32_16x16x32_bf16 v[124:127], v[168:171], v[44:47], v[124:127]
    ds_read_b64_tr_b16 v[164:165], v4 offset:40192
    v_mfma_f32_16x16x32_bf16 v[132:135], v[168:171], v[48:51], v[132:135]
    ds_read_b64_tr_b16 v[166:167], v4 offset:40448
    v_mfma_f32_16x16x32_bf16 v[140:143], v[168:171], v[52:55], v[140:143]
    v_mfma_f32_16x16x32_bf16 v[148:151], v[168:171], v[56:59], v[148:151]
    v_mfma_f32_16x16x32_bf16 v[88:91], v[156:159], v[64:67], v[88:91]
    v_add_u32 v4, s38, v4
    v_mfma_f32_16x16x32_bf16 v[96:99], v[156:159], v[68:71], v[96:99]
    v_add_u32 v2, s38, v2
    v_mfma_f32_16x16x32_bf16 v[104:107], v[156:159], v[72:75], v[104:107]
    v_add_u32 v3, s38, v3
    v_mfma_f32_16x16x32_bf16 v[112:115], v[156:159], v[76:79], v[112:115]
    v_add_u32 v5, s38, v5
    s_waitcnt lgkmcnt(0)
    s_barrier
    v_mfma_f32_16x16x32_bf16 v[92:95], v[160:163], v[64:67], v[92:95]
    ds_read_b64_tr_b16 v[156:157], v4 offset:27520
    v_mfma_f32_16x16x32_bf16 v[100:103], v[160:163], v[68:71], v[100:103]
    ds_read_b64_tr_b16 v[158:159], v4 offset:27776
    v_mfma_f32_16x16x32_bf16 v[108:111], v[160:163], v[72:75], v[108:111]
    ds_read_b128 v[44:47], v2 offset:0
    v_mfma_f32_16x16x32_bf16 v[116:119], v[160:163], v[76:79], v[116:119]
    ds_read_b128 v[48:51], v2 offset:512
    v_mfma_f32_16x16x32_bf16 v[120:123], v[164:167], v[64:67], v[120:123]
    ds_read_b128 v[52:55], v2 offset:8448
    v_mfma_f32_16x16x32_bf16 v[128:131], v[164:167], v[68:71], v[128:131]
    ds_read_b128 v[56:59], v2 offset:8960
    v_mfma_f32_16x16x32_bf16 v[136:139], v[164:167], v[72:75], v[136:139]
    ds_read_b128 v[60:63], v3 offset:0
    v_mfma_f32_16x16x32_bf16 v[144:147], v[164:167], v[76:79], v[144:147]
    ds_read_b64_tr_b16 v[160:161], v5 offset:27520
    v_mfma_f32_16x16x32_bf16 v[152:155], v[164:167], v[80:83], v[152:155]
    ds_read_b64_tr_b16 v[162:163], v5 offset:27776
    v_mfma_f32_16x16x32_bf16 v[124:127], v[220:223], v[64:67], v[124:127]
    ds_read_b64_tr_b16 v[164:165], v4 offset:31744
    v_mfma_f32_16x16x32_bf16 v[132:135], v[220:223], v[68:71], v[132:135]
    ds_read_b64_tr_b16 v[166:167], v4 offset:32000
    v_mfma_f32_16x16x32_bf16 v[140:143], v[220:223], v[72:75], v[140:143]
    ds_read_b64_tr_b16 v[168:169], v5 offset:31744
    v_mfma_f32_16x16x32_bf16 v[148:151], v[220:223], v[76:79], v[148:151]
    ds_read_b64_tr_b16 v[170:171], v5 offset:32000
    s_cbranch_scc1 L_Bl2
    s_waitcnt vmcnt(0)

    s_waitcnt lgkmcnt(5)
    v_mfma_f32_16x16x32_bf16 v[88:91], v[156:159], v[44:47], v[88:91]
    ds_read_b128 v[64:67], v2 offset:64
    v_mfma_f32_16x16x32_bf16 v[96:99], v[156:159], v[48:51], v[96:99]
    ds_read_b128 v[68:71], v2 offset:576
    v_mfma_f32_16x16x32_bf16 v[104:107], v[156:159], v[52:55], v[104:107]
    ds_read_b128 v[72:75], v2 offset:8512
    v_mfma_f32_16x16x32_bf16 v[112:115], v[156:159], v[56:59], v[112:115]
    ds_read_b128 v[76:79], v2 offset:9024
    s_waitcnt lgkmcnt(5)
    v_mfma_f32_16x16x32_bf16 v[92:95], v[160:163], v[44:47], v[92:95]
    ds_read_b128 v[80:83], v3 offset:64
    v_mfma_f32_16x16x32_bf16 v[100:103], v[160:163], v[48:51], v[100:103]
    ds_read_b64_tr_b16 v[156:157], v4 offset:35968
    v_mfma_f32_16x16x32_bf16 v[108:111], v[160:163], v[52:55], v[108:111]
    ds_read_b64_tr_b16 v[158:159], v4 offset:36224
    v_mfma_f32_16x16x32_bf16 v[116:119], v[160:163], v[56:59], v[116:119]
    ds_read_b64_tr_b16 v[160:161], v5 offset:35968
    v_mfma_f32_16x16x32_bf16 v[120:123], v[164:167], v[44:47], v[120:123]
    ds_read_b64_tr_b16 v[162:163], v5 offset:36224
    v_mfma_f32_16x16x32_bf16 v[128:131], v[164:167], v[48:51], v[128:131]
    ds_read_b64_tr_b16 v[212:213], v4 offset:16896
    v_mfma_f32_16x16x32_bf16 v[136:139], v[164:167], v[52:55], v[136:139]
    ds_read_b64_tr_b16 v[214:215], v4 offset:17152
    v_mfma_f32_16x16x32_bf16 v[144:147], v[164:167], v[56:59], v[144:147]
    ds_read_b64_tr_b16 v[216:217], v5 offset:16896
    v_mfma_f32_16x16x32_bf16 v[152:155], v[164:167], v[60:63], v[152:155]
    ds_read_b64_tr_b16 v[218:219], v5 offset:17152
    s_waitcnt lgkmcnt(5)
    v_mfma_f32_16x16x32_bf16 v[88:91], v[156:159], v[64:67], v[88:91]
    ds_read_b64_tr_b16 v[164:165], v4 offset:40192
    v_mfma_f32_16x16x32_bf16 v[96:99], v[156:159], v[68:71], v[96:99]
    ds_read_b64_tr_b16 v[166:167], v4 offset:40448
    v_mfma_f32_16x16x32_bf16 v[104:107], v[156:159], v[72:75], v[104:107]
    s_nop 3
    v_cvt_pk_bf16_f32 v88, v88, v89
    v_cvt_pk_bf16_f32 v89, v90, v91
    ds_write_b64 v84, v[88:89] offset:0
    v_mfma_f32_16x16x32_bf16 v[112:115], v[156:159], v[76:79], v[112:115]
    v_cvt_pk_bf16_f32 v96, v96, v97
    v_cvt_pk_bf16_f32 v97, v98, v99
    ds_write_b64 v84, v[96:97] offset:2048
    s_waitcnt lgkmcnt(5)
    v_mfma_f32_16x16x32_bf16 v[92:95], v[160:163], v[64:67], v[92:95]
    v_cvt_pk_bf16_f32 v104, v104, v105
    v_cvt_pk_bf16_f32 v105, v106, v107
    ds_write_b64 v84, v[104:105] offset:8192
    v_mfma_f32_16x16x32_bf16 v[100:103], v[160:163], v[68:71], v[100:103]
    v_cvt_pk_bf16_f32 v112, v112, v113
    v_cvt_pk_bf16_f32 v113, v114, v115
    ds_write_b64 v84, v[112:113] offset:10240
    v_mfma_f32_16x16x32_bf16 v[108:111], v[160:163], v[72:75], v[108:111]
    v_cvt_pk_bf16_f32 v92, v92, v93
    v_cvt_pk_bf16_f32 v93, v94, v95
    ds_write_b64 v85, v[92:93] offset:0
    v_mfma_f32_16x16x32_bf16 v[116:119], v[160:163], v[76:79], v[116:119]
    v_cvt_pk_bf16_f32 v100, v100, v101
    v_cvt_pk_bf16_f32 v101, v102, v103
    ds_write_b64 v85, v[100:101] offset:2048
    v_mfma_f32_16x16x32_bf16 v[124:127], v[168:171], v[44:47], v[124:127]
    v_cvt_pk_bf16_f32 v108, v108, v109
    v_cvt_pk_bf16_f32 v109, v110, v111
    ds_write_b64 v85, v[108:109] offset:8192
    v_mfma_f32_16x16x32_bf16 v[132:135], v[168:171], v[48:51], v[132:135]
    ds_read_b64_tr_b16 v[220:221], v5 offset:40192
    v_cvt_pk_bf16_f32 v116, v116, v117
    v_cvt_pk_bf16_f32 v117, v118, v119
    ds_write_b64 v85, v[116:117] offset:10240
    v_mfma_f32_16x16x32_bf16 v[140:143], v[168:171], v[52:55], v[140:143]
    ds_read_b64_tr_b16 v[222:223], v5 offset:40448
    v_mfma_f32_16x16x32_bf16 v[148:151], v[168:171], v[56:59], v[148:151]
    ds_read_b64_tr_b16 v[156:157], v4 offset:21120
    s_waitcnt lgkmcnt(6)
    v_mfma_f32_16x16x32_bf16 v[120:123], v[164:167], v[64:67], v[120:123]
    ds_read_b64_tr_b16 v[158:159], v4 offset:21376
    v_mfma_f32_16x16x32_bf16 v[128:131], v[164:167], v[68:71], v[128:131]
    ds_read_b64_tr_b16 v[160:161], v5 offset:21120
    v_mfma_f32_16x16x32_bf16 v[136:139], v[164:167], v[72:75], v[136:139]
    s_nop 3
    v_cvt_pk_bf16_f32 v120, v120, v121
    v_cvt_pk_bf16_f32 v121, v122, v123
    ds_write_b64 v84, v[120:121] offset:44416
    v_mfma_f32_16x16x32_bf16 v[144:147], v[164:167], v[76:79], v[144:147]
    v_cvt_pk_bf16_f32 v128, v128, v129
    v_cvt_pk_bf16_f32 v129, v130, v131
    ds_write_b64 v84, v[128:129] offset:46464
    v_mfma_f32_16x16x32_bf16 v[152:155], v[164:167], v[80:83], v[152:155]
    v_cvt_pk_bf16_f32 v136, v136, v137
    v_cvt_pk_bf16_f32 v137, v138, v139
    ds_write_b64 v84, v[136:137] offset:52608
    s_waitcnt lgkmcnt(5)
    v_mfma_f32_16x16x32_bf16 v[124:127], v[220:223], v[64:67], v[124:127]
    v_cvt_pk_bf16_f32 v144, v144, v145
    v_cvt_pk_bf16_f32 v145, v146, v147
    ds_write_b64 v84, v[144:145] offset:54656
    v_mfma_f32_16x16x32_bf16 v[132:135], v[220:223], v[68:71], v[132:135]
    v_cvt_pk_bf16_f32 v152, v152, v153
    v_cvt_pk_bf16_f32 v153, v154, v155
    ds_write_b64 v206, v[152:153] offset:0
    v_mfma_f32_16x16x32_bf16 v[140:143], v[220:223], v[72:75], v[140:143]
    v_cvt_pk_bf16_f32 v124, v124, v125
    v_cvt_pk_bf16_f32 v125, v126, v127
    ds_write_b64 v85, v[124:125] offset:44416
    v_mfma_f32_16x16x32_bf16 v[148:151], v[220:223], v[76:79], v[148:151]
    v_cvt_pk_bf16_f32 v132, v132, v133
    v_cvt_pk_bf16_f32 v133, v134, v135
    ds_write_b64 v85, v[132:133] offset:46464
    v_mfma_f32_16x16x32_bf16 v[8:11], v[44:47], v[212:215], v[8:11]
    v_cvt_pk_bf16_f32 v140, v140, v141
    v_cvt_pk_bf16_f32 v141, v142, v143
    ds_write_b64 v85, v[140:141] offset:52608
    v_mfma_f32_16x16x32_bf16 v[16:19], v[48:51], v[212:215], v[16:19]
    v_cvt_pk_bf16_f32 v148, v148, v149
    v_cvt_pk_bf16_f32 v149, v150, v151
    ds_write_b64 v85, v[148:149] offset:54656
    v_mfma_f32_16x16x32_bf16 v[24:27], v[52:55], v[212:215], v[24:27]
    ds_read_b64_tr_b16 v[162:163], v5 offset:21376
    v_mfma_f32_16x16x32_bf16 v[32:35], v[56:59], v[212:215], v[32:35]
    s_waitcnt lgkmcnt(0)
    s_barrier
    ds_read2st64_b64 v[88:91], v202 offset0:0 offset1:1
    ds_read2st64_b64 v[92:95], v202 offset0:2 offset1:3
    ds_read2st64_b64 v[96:99], v201 offset0:0 offset1:1
    v_mfma_f32_16x16x32_bf16 v[40:43], v[60:63], v[212:215], v[40:43]
    ds_read2st64_b64 v[100:103], v201 offset0:2 offset1:3
    ds_read2st64_b64 v[104:107], v204 offset0:0 offset1:1
    ds_read2st64_b64 v[108:111], v204 offset0:2 offset1:3
    v_mfma_f32_16x16x32_bf16 v[12:15], v[44:47], v[216:219], v[12:15]
    ds_read_b64_tr_b16 v[164:165], v210 offset:0
    v_mfma_f32_16x16x32_bf16 v[20:23], v[48:51], v[216:219], v[20:23]
    ds_read_b64_tr_b16 v[166:167], v210 offset:256
    v_mfma_f32_16x16x32_bf16 v[28:31], v[52:55], v[216:219], v[28:31]
    ds_read_b128 v[224:227], v6 offset:0
    v_mfma_f32_16x16x32_bf16 v[36:39], v[56:59], v[216:219], v[36:39]
    s_waitcnt lgkmcnt(6)
    v_cndmask_b32 v112, 0, v88, s[40:41]
    v_cndmask_b32 v113, 0, v89, s[42:43]
    v_cndmask_b32 v126, v94, 0, s[52:53]
    v_mfma_f32_16x16x32_bf16 v[8:11], v[64:67], v[156:159], v[8:11]
    v_cndmask_b32 v127, v95, 0, s[54:55]
    v_mfma_f32_16x16x16_bf16 v[128:131], v[96:97], v[112:113], v[192:195]
    s_waitcnt lgkmcnt(2)
    v_mfma_f32_16x16x16_bf16 v[132:135], v[102:103], v[126:127], v[192:195]
    v_mfma_f32_16x16x32_bf16 v[16:19], v[68:71], v[156:159], v[16:19]
    v_mfma_f32_16x16x16_bf16 v[148:151], v[104:105], v[112:113], v[192:195]
    v_mfma_f32_16x16x16_bf16 v[152:155], v[110:111], v[126:127], v[192:195]
    v_cndmask_b32 v114, v88, 0, s[40:41]
    v_mfma_f32_16x16x32_bf16 v[24:27], v[72:75], v[156:159], v[24:27]
    ds_read_b128 v[228:231], v6 offset:512
    v_cndmask_b32 v115, v89, 0, s[42:43]
    v_cndmask_b32 v116, 0, v90, s[44:45]
    v_cndmask_b32 v117, 0, v91, s[46:47]
    v_mfma_f32_16x16x32_bf16 v[32:35], v[76:79], v[156:159], v[32:35]
    ds_read_b128 v[232:235], v6 offset:8448
    v_cndmask_b32 v118, v90, 0, s[44:45]
    v_cndmask_b32 v119, v91, 0, s[46:47]
    s_mov_b64 exec, s[100:101]
    v_mov_b64 v[128:129], v[148:149]
    v_mov_b64 v[130:131], v[150:151]
    v_mov_b64 v[132:133], v[152:153]
    v_mov_b64 v[134:135], v[154:155]
    s_mov_b64 exec, -1
    v_mfma_f32_16x16x32_bf16 v[40:43], v[80:83], v[156:159], v[40:43]
    ds_read_b128 v[236:239], v6 offset:8960
    v_min_u32 v128, -2, v128
    buffer_store_dwordx4 v[128:131], v248, s[24:27], s76 offen sc1
    v_min_u32 v132, -2, v132
    v_mfma_f32_16x16x32_bf16 v[12:15], v[64:67], v[160:163], v[12:15]
    ds_read_b128 v[240:243], v7 offset:0
    buffer_store_dwordx4 v[132:135], v248, s[24:27], s77 offen sc1
    v_cndmask_b32 v120, 0, v92, s[48:49]
    v_cndmask_b32 v121, 0, v93, s[50:51]
    v_mfma_f32_16x16x32_bf16 v[20:23], v[68:71], v[160:163], v[20:23]
    ds_read_b64_tr_b16 v[168:169], v211 offset:0
    v_cndmask_b32 v122, v92, 0, s[48:49]
    v_cndmask_b32 v123, v93, 0, s[50:51]
    v_cndmask_b32 v124, 0, v94, s[52:53]
    v_mfma_f32_16x16x32_bf16 v[28:31], v[72:75], v[160:163], v[28:31]
    ds_read_b64_tr_b16 v[170:171], v211 offset:256
    v_cndmask_b32 v125, 0, v95, s[54:55]
    v_mfma_f32_16x16x32_bf16 v[36:39], v[76:79], v[160:163], v[36:39]
    ds_read_b64_tr_b16 v[212:213], v210 offset:4224
    s_waitcnt lgkmcnt(5)
    v_mfma_f32_16x16x32_bf16 v[8:11], v[224:227], v[164:167], v[8:11]
    ds_read_b64_tr_b16 v[214:215], v210 offset:4480
    v_mfma_f32_16x16x32_bf16 v[16:19], v[228:231], v[164:167], v[16:19]
    ds_read_b128 v[44:47], v6 offset:64
    v_mfma_f32_16x16x32_bf16 v[24:27], v[232:235], v[164:167], v[24:27]
    ds_read_b128 v[48:51], v6 offset:576
    s_waitcnt lgkmcnt(5)
    v_mfma_f32_16x16x32_bf16 v[32:35], v[236:239], v[164:167], v[32:35]
    ds_read_b128 v[52:55], v6 offset:8512
    v_mfma_f32_16x16x32_bf16 v[40:43], v[240:243], v[164:167], v[40:43]
    ds_read_b128 v[56:59], v6 offset:9024
    s_waitcnt lgkmcnt(5)
    v_mfma_f32_16x16x32_bf16 v[12:15], v[224:227], v[168:171], v[12:15]
    ds_read_b128 v[60:63], v7 offset:64
    v_mfma_f32_16x16x32_bf16 v[20:23], v[228:231], v[168:171], v[20:23]
    ds_read_b64_tr_b16 v[216:217], v211 offset:4224
    v_mfma_f32_16x16x32_bf16 v[28:31], v[232:235], v[168:171], v[28:31]
    ds_read_b64_tr_b16 v[218:219], v211 offset:4480
    v_mfma_f32_16x16x32_bf16 v[36:39], v[236:239], v[168:171], v[36:39]
    ds_read_b64_tr_b16 v[156:157], v210 offset:44416
    s_waitcnt lgkmcnt(5)
    v_mfma_f32_16x16x32_bf16 v[8:11], v[44:47], v[212:215], v[8:11]
    ds_read_b64_tr_b16 v[158:159], v210 offset:44672
    v_mfma_f32_16x16x32_bf16 v[16:19], v[48:51], v[212:215], v[16:19]
    ds_read_b128 v[64:67], v6 offset:44416
    v_mfma_f32_16x16x32_bf16 v[24:27], v[52:55], v[212:215], v[24:27]
    ds_read_b128 v[68:71], v6 offset:44928
    s_waitcnt lgkmcnt(5)
    v_mfma_f32_16x16x32_bf16 v[32:35], v[56:59], v[212:215], v[32:35]
    ds_read_b128 v[72:75], v6 offset:52864
    v_mfma_f32_16x16x32_bf16 v[40:43], v[60:63], v[212:215], v[40:43]
    ds_read_b128 v[76:79], v6 offset:53376
    s_waitcnt lgkmcnt(5)
    v_mfma_f32_16x16x32_bf16 v[12:15], v[44:47], v[216:219], v[12:15]
    ds_read_b128 v[80:83], v7 offset:44416
    v_mfma_f32_16x16x32_bf16 v[20:23], v[48:51], v[216:219], v[20:23]
    ds_read_b64_tr_b16 v[160:161], v211 offset:44416
    v_mfma_f32_16x16x32_bf16 v[28:31], v[52:55], v[216:219], v[28:31]
    ds_read_b64_tr_b16 v[162:163], v211 offset:44672
    v_mfma_f32_16x16x32_bf16 v[36:39], v[56:59], v[216:219], v[36:39]
    ds_read_b64_tr_b16 v[164:165], v210 offset:48640
    s_waitcnt lgkmcnt(5)
    v_mfma_f32_16x16x32_bf16 v[8:11], v[64:67], v[156:159], v[8:11]
    ds_read_b64_tr_b16 v[166:167], v210 offset:48896
    v_mfma_f32_16x16x32_bf16 v[16:19], v[68:71], v[156:159], v[16:19]
    ds_read_b128 v[224:227], v6 offset:44480
    v_mfma_f32_16x16x32_bf16 v[24:27], v[72:75], v[156:159], v[24:27]
    ds_read_b128 v[228:231], v6 offset:44992
    s_waitcnt lgkmcnt(5)
    v_mfma_f32_16x16x32_bf16 v[32:35], v[76:79], v[156:159], v[32:35]
    ds_read_b128 v[232:235], v6 offset:52928
    v_mfma_f32_16x16x32_bf16 v[40:43], v[80:83], v[156:159], v[40:43]
    ds_read_b128 v[236:239], v6 offset:53440
    s_waitcnt lgkmcnt(5)
    v_mfma_f32_16x16x32_bf16 v[12:15], v[64:67], v[160:163], v[12:15]
    ds_read_b128 v[240:243], v7 offset:44480
    v_mfma_f32_16x16x32_bf16 v[20:23], v[68:71], v[160:163], v[20:23]
    ds_read_b64_tr_b16 v[168:169], v211 offset:48640
    v_mfma_f32_16x16x32_bf16 v[28:31], v[72:75], v[160:163], v[28:31]
    ds_read_b64_tr_b16 v[170:171], v211 offset:48896
    v_mfma_f32_16x16x32_bf16 v[36:39], v[76:79], v[160:163], v[36:39]
    s_waitcnt lgkmcnt(4)
    v_mfma_f32_16x16x32_bf16 v[8:11], v[224:227], v[164:167], v[8:11]
    v_mfma_f32_16x16x32_bf16 v[16:19], v[228:231], v[164:167], v[16:19]
    v_mfma_f32_16x16x32_bf16 v[24:27], v[232:235], v[164:167], v[24:27]
    s_nop 5
    v_cvt_pk_bf16_f32 v8, v8, v9
    v_cvt_pk_bf16_f32 v9, v10, v11
    ds_write_b64 v86, v[8:9] offset:0
    s_waitcnt lgkmcnt(2)
    v_mfma_f32_16x16x32_bf16 v[32:35], v[236:239], v[164:167], v[32:35]
    v_cvt_pk_bf16_f32 v16, v16, v17
    v_cvt_pk_bf16_f32 v17, v18, v19
    ds_write_b64 v86, v[16:17] offset:2048
    v_mfma_f32_16x16x32_bf16 v[40:43], v[240:243], v[164:167], v[40:43]
    v_cvt_pk_bf16_f32 v24, v24, v25
    v_cvt_pk_bf16_f32 v25, v26, v27
    ds_write_b64 v86, v[24:25] offset:8192
    s_waitcnt lgkmcnt(3)
    v_mfma_f32_16x16x32_bf16 v[12:15], v[224:227], v[168:171], v[12:15]
    v_cvt_pk_bf16_f32 v32, v32, v33
    v_cvt_pk_bf16_f32 v33, v34, v35
    ds_write_b64 v86, v[32:33] offset:10240
    v_mfma_f32_16x16x32_bf16 v[20:23], v[228:231], v[168:171], v[20:23]
    v_cvt_pk_bf16_f32 v40, v40, v41
    v_cvt_pk_bf16_f32 v41, v42, v43
    ds_write_b64 v206, v[40:41] offset:2048
    v_mfma_f32_16x16x32_bf16 v[28:31], v[232:235], v[168:171], v[28:31]
    v_cvt_pk_bf16_f32 v12, v12, v13
    v_cvt_pk_bf16_f32 v13, v14, v15
    ds_write_b64 v87, v[12:13] offset:0
    v_mfma_f32_16x16x32_bf16 v[36:39], v[236:239], v[168:171], v[36:39]
    v_cvt_pk_bf16_f32 v20, v20, v21
    v_cvt_pk_bf16_f32 v21, v22, v23
    ds_write_b64 v87, v[20:21] offset:2048
    s_nop 0
    v_cvt_pk_bf16_f32 v28, v28, v29
    v_cvt_pk_bf16_f32 v29, v30, v31
    ds_write_b64 v87, v[28:29] offset:8192
    s_nop 0
    v_cvt_pk_bf16_f32 v36, v36, v37
    v_cvt_pk_bf16_f32 v37, v38, v39
    ds_write_b64 v87, v[36:37] offset:10240
    s_waitcnt lgkmcnt(0)
    s_barrier
    ds_read_b64 v[228:229], v203 offset:512
    ds_read_b64 v[230:231], v205 offset:512
    ds_read_b64 v[232:233], v203 offset:1024
    ds_read_b64 v[234:235], v205 offset:1024
    ds_read_b64 v[224:225], v203 offset:0
    ds_read_b64 v[226:227], v205 offset:0
    ds_read_b64 v[236:237], v203 offset:1536
    ds_read_b64 v[238:239], v205 offset:1536
L_BF:
    v_mfma_f32_16x16x32_bf16 v[148:151], v[104:107], v[114:117], v[192:195]
    v_mfma_f32_16x16x32_bf16 v[136:139], v[96:99], v[114:117], v[192:195]
    v_mfma_f32_16x16x32_bf16 v[152:155], v[106:109], v[118:121], v[192:195]
    v_mfma_f32_16x16x32_bf16 v[140:143], v[98:101], v[118:121], v[192:195]
    v_mfma_f32_16x16x32_bf16 v[156:159], v[108:111], v[122:125], v[192:195]
    v_mfma_f32_16x16x32_bf16 v[144:147], v[100:103], v[122:125], v[192:195]
    s_mov_b64 exec, s[100:101]
    s_nop 2
    v_mov_b64 v[136:137], v[148:149]
    v_mov_b64 v[138:139], v[150:151]
    v_mov_b64 v[140:141], v[152:153]
    v_mov_b64 v[142:143], v[154:155]
    v_mov_b64 v[144:145], v[156:157]
    v_mov_b64 v[146:147], v[158:159]
    s_mov_b64 exec, -1
    v_max3_f32 v160, v136, v137, v138
    v_max3_f32 v161, v140, v141, v142
    v_max3_f32 v162, v144, v145, v146
    v_max_f32 v160, v160, v139
    v_max_f32 v161, v161, v143
    v_max_f32 v162, v162, v147
    v_mov_b32 v163, v162
    v_permlane32_swap_b32 v160, v161
    s_nop 0
    v_permlane32_swap_b32 v162, v163
    v_max_f32 v160, v160, v161
    v_max_f32 v162, v162, v163
    s_nop 1
    v_permlane16_swap_b32 v160, v162
    v_max_f32 v160, v160, v162
    v_mul_f32 v162, s70, v160
    v_mul_f32 v160, s70, v160
    s_nop 1
    v_permlane16_swap_b32 v160, v162
    v_mov_b32 v161, v160
    s_nop 1
    v_permlane32_swap_b32 v160, v161
    s_cmp_ge_u32 s3, 4
    s_cbranch_scc1 L_Bi
    buffer_load_dwordx4 v[216:219], v248, s[24:27], s78 offen sc1
    buffer_load_dwordx4 v[220:223], v248, s[24:27], s79 offen sc1
L_Bi:
    v_fma_f32 v144, v144, s70, -v162
    v_fma_f32 v145, v145, s70, -v162
    v_fma_f32 v146, v146, s70, -v162
    v_fma_f32 v147, v147, s70, -v162
    v_exp_f32 v144, v144
    v_exp_f32 v145, v145
    v_exp_f32 v146, v146
    v_exp_f32 v147, v147
    v_fma_f32 v140, v140, s70, -v161
    v_fma_f32 v141, v141, s70, -v161
    v_fma_f32 v142, v142, s70, -v161
    v_fma_f32 v143, v143, s70, -v161
    v_exp_f32 v140, v140
    v_exp_f32 v141, v141
    v_exp_f32 v142, v142
    v_exp_f32 v143, v143
    v_fma_f32 v136, v136, s70, -v160
    v_fma_f32 v137, v137, s70, -v160
    v_fma_f32 v138, v138, s70, -v160
    v_fma_f32 v139, v139, s70, -v160
    v_exp_f32 v136, v136
    v_exp_f32 v137, v137
    v_exp_f32 v138, v138
    v_exp_f32 v139, v139

    v_add_f32 v152, v144, v145
    v_add_f32 v153, v146, v147
    v_add_f32 v150, v140, v141
    v_add_f32 v151, v142, v143
    v_add_f32 v148, v136, v137
    v_add_f32 v149, v138, v139
    v_add_f32 v162, v152, v153
    v_add_f32 v161, v150, v151
    v_add_f32 v160, v148, v149
    v_mov_b32 v163, v162
    s_nop 0
    v_permlane32_swap_b32 v160, v161
    v_permlane32_swap_b32 v162, v163
    v_add_f32 v160, v160, v161
    v_add_f32 v162, v162, v163
    s_nop 1
    v_permlane16_swap_b32 v160, v162
    v_add_f32 v160, v160, v162
    v_rcp_f32 v162, v160
    v_rcp_f32 v160, v160
    s_nop 1
    v_permlane16_swap_b32 v160, v162
    v_mov_b32 v161, v160
    s_nop 1
    v_permlane32_swap_b32 v160, v161
    v_mul_f32 v144, v144, v162
    v_mul_f32 v145, v145, v162
    v_mul_f32 v146, v146, v162
    v_mul_f32 v147, v147, v162
    v_mul_f32 v140, v140, v161
    v_mul_f32 v141, v141, v161
    v_mul_f32 v142, v142, v161
    v_mul_f32 v143, v143, v161
    v_mul_f32 v136, v136, v160
    v_mul_f32 v137, v137, v160
    v_mul_f32 v138, v138, v160
    v_mul_f32 v139, v139, v160
    s_not_b64 exec, s[100:101]
    v_cvt_pk_bf16_f32 v184, v144, v145
    v_cvt_pk_bf16_f32 v185, v146, v147
    v_cvt_pk_bf16_f32 v180, v140, v141
    v_cvt_pk_bf16_f32 v181, v142, v143
    v_cvt_pk_bf16_f32 v176, v136, v137
    v_cvt_pk_bf16_f32 v177, v138, v139
    s_mov_b64 exec, s[100:101]
    v_cvt_pk_bf16_f32 v186, v144, v145
    v_cvt_pk_bf16_f32 v187, v146, v147
    v_cvt_pk_bf16_f32 v182, v140, v141
    v_cvt_pk_bf16_f32 v183, v142, v143
    v_cvt_pk_bf16_f32 v178, v136, v137
    v_cvt_pk_bf16_f32 v179, v138, v139
    s_mov_b64 exec, -1
    s_cmp_lt_u32 s3, 4
    s_cbranch_scc1 L_Bw
    s_waitcnt vmcnt(0)
    s_cmp_lg_u32 s3, 4
    s_cbranch_scc1 L_Bv2
    s_movk_i32 s5, 3750
    s_mov_b64 exec, 0x3f
L_Bv1:
    v_cmp_ne_u32 vcc, v87, v249
    s_cbranch_vccz L_Bv2
    s_sleep 8
    buffer_load_dword v87, v200, s[24:27], s67 offen sc1
    s_sub_u32 s5, s5, 1
    s_waitcnt vmcnt(0)
    s_cbranch_scc0 L_Bv1
L_Bv2:
    s_mov_b64 exec, -1
    s_barrier
    ds_read_b64 v[228:229], v203 offset:512
    ds_read_b64 v[230:231], v205 offset:512
    ds_read_b64 v[232:233], v203 offset:1024
    ds_read_b64 v[234:235], v205 offset:1024
    ds_read_b64 v[224:225], v203 offset:0
    ds_read_b64 v[226:227], v205 offset:0
    ds_read_b64 v[236:237], v203 offset:1536
    ds_read_b64 v[238:239], v205 offset:1536
    buffer_load_dwordx4 v[216:219], v248, s[24:27], s78 offen sc1
    buffer_load_dwordx4 v[220:223], v248, s[24:27], s79 offen sc1
L_Bw:
    s_waitcnt lgkmcnt(4)
    v_mfma_f32_16x16x32_bf16 v[100:103], v[228:231], v[180:183], 0
    v_mfma_f32_16x16x32_bf16 v[108:111], v[232:235], v[184:187], 0
    v_mfma_f32_16x16x32_bf16 v[96:99], v[228:231], v[176:179], 0
    v_mfma_f32_16x16x32_bf16 v[104:107], v[232:235], v[180:183], 0
    s_waitcnt lgkmcnt(0)
    v_mfma_f32_16x16x32_bf16 v[92:95], v[224:227], v[176:179], 0
    v_mfma_f32_16x16x32_bf16 v[112:115], v[236:239], v[184:187], 0
    s_nop 1
    v_cvt_pk_bf16_f32 v8, v100, v101
    v_cvt_pk_bf16_f32 v9, v102, v103
    v_cvt_pk_bf16_f32 v10, v108, v109
    v_cvt_pk_bf16_f32 v11, v110, v111
    s_mov_b64 exec, s[44:45]
    v_cvt_pk_bf16_f32 v8, v96, v97
    s_mov_b64 exec, s[46:47]
    v_cvt_pk_bf16_f32 v9, v98, v99
    s_mov_b64 exec, s[48:49]
    v_cvt_pk_bf16_f32 v10, v104, v105
    s_mov_b64 exec, s[50:51]
    v_cvt_pk_bf16_f32 v11, v106, v107
    s_mov_b64 exec, -1
    v_min_u32 v8, -2, v8
    buffer_store_dwordx4 v[8:11], v248, s[24:27], s74 offen sc1
    s_cmp_lt_u32 s3, 4
    s_cbranch_scc1 L_Bw2
    ds_write_b128 v85, v[48:51] offset:0
    ds_write_b128 v85, v[52:55] offset:4224
    ds_write_b128 v85, v[56:59] offset:8448
    ds_write_b128 v85, v[60:63] offset:12672
    ds_write_b128 v85, v[64:67] offset:16896
    ds_write_b128 v85, v[68:71] offset:44416
    ds_write_b128 v85, v[72:75] offset:48640
    ds_write_b128 v85, v[76:79] offset:52864
    ds_write_b128 v85, v[4:7] offset:57088
    s_waitcnt vmcnt(1)
    s_branch L_Bw3
L_Bw2:
    v_add_u32 v255, s68, v248
    ds_write_b128 v255, v[8:11]
    s_waitcnt lgkmcnt(0)
    s_barrier
    s_waitcnt vmcnt(1)
L_Bw3:
    s_movk_i32 s5, 30000
L_By:
    v_max_u32 v148, v216, v220
    v_cmp_eq_u32 vcc, -1, v148
    s_cbranch_vccz L_Byd
    buffer_load_dwordx4 v[216:219], v248, s[24:27], s78 offen sc1
    buffer_load_dwordx4 v[220:223], v248, s[24:27], s79 offen sc1
    s_sub_u32 s5, s5, 1
    s_waitcnt vmcnt(0)
    s_cbranch_scc0 L_By
L_Byd:
    v_add_f32 v128, v128, v216
    v_add_f32 v129, v129, v217
    v_add_f32 v130, v130, v218
    v_add_f32 v131, v131, v219
    v_add_f32 v132, v132, v220
    v_add_f32 v133, v133, v221
    v_add_f32 v134, v134, v222
    v_add_f32 v135, v135, v223
    v_max3_f32 v160, v128, v129, v130
    v_max3_f32 v161, v132, v133, v134
    v_max_f32 v160, v160, v131
    v_max_f32 v161, v161, v135
    s_nop 1
    v_permlane32_swap_b32 v160, v161
    v_max_f32 v163, v160, v161
    v_max_f32 v160, v160, v161
    s_nop 1
    v_permlane16_swap_b32 v160, v163
    v_max_f32 v160, v160, v163
    v_mul_f32 v161, s70, v160
    v_mul_f32 v160, s70, v160
    s_nop 1
    v_permlane32_swap_b32 v160, v161

    v_fma_f32 v132, v132, s70, -v161
    v_fma_f32 v133, v133, s70, -v161
    v_fma_f32 v134, v134, s70, -v161
    v_fma_f32 v135, v135, s70, -v161
    v_exp_f32 v132, v132
    v_exp_f32 v133, v133
    v_exp_f32 v134, v134
    v_exp_f32 v135, v135
    v_fma_f32 v128, v128, s70, -v160
    v_fma_f32 v129, v129, s70, -v160
    v_fma_f32 v130, v130, s70, -v160
    v_fma_f32 v131, v131, s70, -v160
    v_exp_f32 v128, v128
    v_exp_f32 v129, v129
    v_exp_f32 v130, v130
    v_exp_f32 v131, v131

    v_add_f32 v150, v132, v133
    v_add_f32 v151, v134, v135
    v_add_f32 v148, v128, v129
    v_add_f32 v149, v130, v131
    v_add_f32 v161, v150, v151
    v_add_f32 v160, v148, v149
    s_nop 1
    v_permlane32_swap_b32 v160, v161
    v_add_f32 v163, v160, v161
    v_add_f32 v160, v160, v161
    s_nop 1
    v_permlane16_swap_b32 v160, v163
    v_add_f32 v160, v160, v163
    v_rcp_f32 v161, v160
    v_rcp_f32 v160, v160
    s_nop 1
    v_permlane32_swap_b32 v160, v161
    v_mul_f32 v132, v132, v161
    v_mul_f32 v133, v133, v161
    v_mul_f32 v134, v134, v161
    v_mul_f32 v135, v135, v161
    v_mul_f32 v128, v128, v160
    v_mul_f32 v129, v129, v160
    v_mul_f32 v130, v130, v160
    v_mul_f32 v131, v131, v160
    s_not_b64 exec, s[100:101]
    v_cvt_pk_bf16_f32 v188, v132, v133
    v_cvt_pk_bf16_f32 v189, v134, v135
    v_cvt_pk_bf16_f32 v172, v128, v129
    v_cvt_pk_bf16_f32 v173, v130, v131
    s_mov_b64 exec, s[100:101]
    v_cvt_pk_bf16_f32 v190, v132, v133
    v_cvt_pk_bf16_f32 v191, v134, v135
    v_cvt_pk_bf16_f32 v174, v128, v129
    v_cvt_pk_bf16_f32 v175, v130, v131
    s_mov_b64 exec, -1
    v_mfma_f32_16x16x32_bf16 v[116:119], v[236:239], v[188:191], 0
    v_mfma_f32_16x16x32_bf16 v[88:91], v[224:227], v[172:175], 0
    v_cvt_pk_bf16_f32 v44, v92, v93
    v_cvt_pk_bf16_f32 v45, v94, v95
    s_nop 4
    v_cvt_pk_bf16_f32 v46, v116, v117
    v_cvt_pk_bf16_f32 v47, v118, v119
    s_mov_b64 exec, s[40:41]
    v_cvt_pk_bf16_f32 v44, v88, v89
    s_mov_b64 exec, s[42:43]
    v_cvt_pk_bf16_f32 v45, v90, v91
    s_mov_b64 exec, s[52:53]
    v_cvt_pk_bf16_f32 v46, v112, v113
    s_mov_b64 exec, s[54:55]
    v_cvt_pk_bf16_f32 v47, v114, v115
    s_mov_b64 exec, -1
    v_min_u32 v44, -2, v44
    s_add_u32 s74, s74, 18432
    buffer_store_dwordx4 v[44:47], v248, s[24:27], s74 offen sc1
    s_cmp_lt_u32 s3, 4
    s_cbranch_scc1 L_Bp0
    v_add_u32 v255, s68, v248
    ds_write_b128 v255, v[44:47]
    v_add_u32 v255, s65, v248
    s_waitcnt lgkmcnt(0)
    s_barrier
    ds_read_b128 v[44:47], v255
    s_branch L_Bp1
L_Bp0:
    v_add_u32 v255, s65, v248
    ds_read_b128 v[8:11], v255

L_Bp1:
    s_movk_i32 s5, 30000
    buffer_load_dwordx4 v[12:15], v248, s[12:15], s57 offen sc1
    ds_read_b64_tr_b16 v[88:89], v250 offset:0
    ds_read_b64_tr_b16 v[90:91], v250 offset:512
    ds_read_b64_tr_b16 v[92:93], v250 offset:32
    ds_read_b64_tr_b16 v[94:95], v250 offset:544
    ds_read_b64_tr_b16 v[96:97], v250 offset:64
    ds_read_b64_tr_b16 v[98:99], v250 offset:576
    ds_read_b64_tr_b16 v[100:101], v250 offset:96
    ds_read_b64_tr_b16 v[102:103], v250 offset:608
    buffer_load_dwordx4 v[16:19], v248, s[12:15], s58 offen sc1
    ds_read_b64_tr_b16 v[104:105], v250 offset:4224
    ds_read_b64_tr_b16 v[106:107], v250 offset:4736
    ds_read_b64_tr_b16 v[108:109], v250 offset:4256
    ds_read_b64_tr_b16 v[110:111], v250 offset:4768
    ds_read_b64_tr_b16 v[112:113], v250 offset:4288
    ds_read_b64_tr_b16 v[114:115], v250 offset:4800
    ds_read_b64_tr_b16 v[116:117], v250 offset:4320
    ds_read_b64_tr_b16 v[118:119], v250 offset:4832
    buffer_load_dwordx4 v[20:23], v248, s[12:15], s59 offen sc1
    ds_read_b64_tr_b16 v[120:121], v250 offset:8448
    ds_read_b64_tr_b16 v[122:123], v250 offset:8960
    ds_read_b64_tr_b16 v[124:125], v250 offset:8480
    ds_read_b64_tr_b16 v[126:127], v250 offset:8992
    ds_read_b64_tr_b16 v[128:129], v250 offset:8512
    ds_read_b64_tr_b16 v[130:131], v250 offset:9024
    ds_read_b64_tr_b16 v[132:133], v250 offset:8544
    ds_read_b64_tr_b16 v[134:135], v250 offset:9056
    buffer_load_dwordx4 v[24:27], v248, s[12:15], s60 offen sc1
    ds_read_b64_tr_b16 v[136:137], v250 offset:12672
    ds_read_b64_tr_b16 v[138:139], v250 offset:13184
    ds_read_b64_tr_b16 v[140:141], v250 offset:12704
    ds_read_b64_tr_b16 v[142:143], v250 offset:13216
    ds_read_b64_tr_b16 v[144:145], v250 offset:12736
    ds_read_b64_tr_b16 v[146:147], v250 offset:13248
    ds_read_b64_tr_b16 v[148:149], v250 offset:12768
    ds_read_b64_tr_b16 v[150:151], v250 offset:13280
    buffer_load_dwordx4 v[28:31], v248, s[12:15], s61 offen sc1
    ds_read_b64_tr_b16 v[152:153], v250 offset:16896
    ds_read_b64_tr_b16 v[154:155], v250 offset:17408
    ds_read_b64_tr_b16 v[156:157], v250 offset:16928
    ds_read_b64_tr_b16 v[158:159], v250 offset:17440
    ds_read_b64_tr_b16 v[160:161], v250 offset:16960
    ds_read_b64_tr_b16 v[162:163], v250 offset:17472
    ds_read_b64_tr_b16 v[164:165], v250 offset:16992
    ds_read_b64_tr_b16 v[166:167], v250 offset:17504
    buffer_load_dwordx4 v[32:35], v248, s[12:15], s62 offen sc1
    ds_read_b64_tr_b16 v[168:169], v251 offset:0
    ds_read_b64_tr_b16 v[170:171], v251 offset:512
    ds_read_b64_tr_b16 v[172:173], v251 offset:32
    ds_read_b64_tr_b16 v[174:175], v251 offset:544
    ds_read_b64_tr_b16 v[176:177], v251 offset:64
    ds_read_b64_tr_b16 v[178:179], v251 offset:576
    ds_read_b64_tr_b16 v[180:181], v251 offset:96
    ds_read_b64_tr_b16 v[182:183], v251 offset:608
    buffer_load_dwordx4 v[36:39], v248, s[12:15], s63 offen sc1
    ds_read_b64_tr_b16 v[184:185], v251 offset:4224
    ds_read_b64_tr_b16 v[186:187], v251 offset:4736
    ds_read_b64_tr_b16 v[188:189], v251 offset:4256
    ds_read_b64_tr_b16 v[190:191], v251 offset:4768
    ds_read_b64_tr_b16 v[192:193], v251 offset:4288
    ds_read_b64_tr_b16 v[194:195], v251 offset:4800
    ds_read_b64_tr_b16 v[196:197], v251 offset:4320
    ds_read_b64_tr_b16 v[198:199], v251 offset:4832
    buffer_load_dwordx4 v[40:43], v248, s[12:15], s75 offen sc1
    ds_read_b64_tr_b16 v[200:201], v251 offset:8448
    ds_read_b64_tr_b16 v[202:203], v251 offset:8960
    ds_read_b64_tr_b16 v[204:205], v251 offset:8480
    ds_read_b64_tr_b16 v[206:207], v251 offset:8992
    ds_read_b64_tr_b16 v[208:209], v251 offset:8512
    ds_read_b64_tr_b16 v[210:211], v251 offset:9024
    ds_read_b64_tr_b16 v[212:213], v251 offset:8544
    ds_read_b64_tr_b16 v[214:215], v251 offset:9056
    ds_read_b64_tr_b16 v[216:217], v251 offset:12672
    ds_read_b64_tr_b16 v[218:219], v251 offset:13184
    ds_read_b64_tr_b16 v[220:221], v251 offset:12704
    ds_read_b64_tr_b16 v[222:223], v251 offset:13216
    ds_read_b64_tr_b16 v[224:225], v251 offset:12736
    ds_read_b64_tr_b16 v[226:227], v251 offset:13248
    ds_read_b64_tr_b16 v[228:229], v251 offset:12768
    ds_read_b64_tr_b16 v[230:231], v251 offset:13280
    v_add_u32 v250, s71, v248
    v_add_u32 v251, s72, v248

    s_waitcnt vmcnt(6)
    v_max3_u32 v249, v12, v12, v16
    v_cmp_eq_u32 vcc, -1, v249
    s_cbranch_vccnz L_Bk00r
L_Bk00d:
    s_waitcnt lgkmcnt(8)
    v_mfma_f32_16x16x32_bf16 v[232:235], v[88:91], v[8:11], 0
    buffer_load_dwordx4 v[48:51], v248, s[24:27], s57 offen sc1
    v_mfma_f32_16x16x32_bf16 v[236:239], v[92:95], v[8:11], 0
    v_mfma_f32_16x16x32_bf16 v[240:243], v[96:99], v[8:11], 0
    v_mfma_f32_16x16x32_bf16 v[244:247], v[100:103], v[8:11], 0
    v_mfma_f32_16x16x32_bf16 v[232:235], v[104:107], v[12:15], v[232:235]
    buffer_load_dwordx4 v[52:55], v248, s[24:27], s58 offen sc1
    v_mfma_f32_16x16x32_bf16 v[236:239], v[108:111], v[12:15], v[236:239]
    v_mfma_f32_16x16x32_bf16 v[240:243], v[112:115], v[12:15], v[240:243]
    v_mfma_f32_16x16x32_bf16 v[244:247], v[116:119], v[12:15], v[244:247]
    v_mfma_f32_16x16x32_bf16 v[232:235], v[120:123], v[16:19], v[232:235]
    buffer_load_dwordx4 v[56:59], v248, s[24:27], s59 offen sc1
    v_mfma_f32_16x16x32_bf16 v[236:239], v[124:127], v[16:19], v[236:239]
    s_waitcnt vmcnt(6)
    v_max3_u32 v249, v20, v24, v28
    v_mfma_f32_16x16x32_bf16 v[240:243], v[128:131], v[16:19], v[240:243]
    v_cmp_eq_u32 vcc, -1, v249
    v_mfma_f32_16x16x32_bf16 v[244:247], v[132:135], v[16:19], v[244:247]
    s_cbranch_vccnz L_Bk01r
L_Bk01d:
    v_mfma_f32_16x16x32_bf16 v[232:235], v[136:139], v[20:23], v[232:235]
    buffer_load_dwordx4 v[60:63], v248, s[24:27], s60 offen sc1
    v_mfma_f32_16x16x32_bf16 v[236:239], v[140:143], v[20:23], v[236:239]
    v_mfma_f32_16x16x32_bf16 v[240:243], v[144:147], v[20:23], v[240:243]
    v_mfma_f32_16x16x32_bf16 v[244:247], v[148:151], v[20:23], v[244:247]
    v_mfma_f32_16x16x32_bf16 v[232:235], v[152:155], v[24:27], v[232:235]
    buffer_load_dwordx4 v[64:67], v248, s[24:27], s61 offen sc1
    v_mfma_f32_16x16x32_bf16 v[236:239], v[156:159], v[24:27], v[236:239]
    v_mfma_f32_16x16x32_bf16 v[240:243], v[160:163], v[24:27], v[240:243]
    v_mfma_f32_16x16x32_bf16 v[244:247], v[164:167], v[24:27], v[244:247]
    v_mfma_f32_16x16x32_bf16 v[232:235], v[168:171], v[28:31], v[232:235]
    buffer_load_dwordx4 v[68:71], v248, s[24:27], s62 offen sc1
    v_mfma_f32_16x16x32_bf16 v[236:239], v[172:175], v[28:31], v[236:239]
    s_waitcnt vmcnt(6)
    v_max3_u32 v249, v32, v36, v40
    v_mfma_f32_16x16x32_bf16 v[240:243], v[176:179], v[28:31], v[240:243]
    v_cmp_eq_u32 vcc, -1, v249
    v_mfma_f32_16x16x32_bf16 v[244:247], v[180:183], v[28:31], v[244:247]
    s_cbranch_vccnz L_Bk02r
L_Bk02d:
    v_mfma_f32_16x16x32_bf16 v[232:235], v[184:187], v[32:35], v[232:235]
    buffer_load_dwordx4 v[72:75], v248, s[24:27], s63 offen sc1
    v_mfma_f32_16x16x32_bf16 v[236:239], v[188:191], v[32:35], v[236:239]
    v_mfma_f32_16x16x32_bf16 v[240:243], v[192:195], v[32:35], v[240:243]
    v_mfma_f32_16x16x32_bf16 v[244:247], v[196:199], v[32:35], v[244:247]
    v_mfma_f32_16x16x32_bf16 v[232:235], v[200:203], v[36:39], v[232:235]
    buffer_load_dwordx4 v[76:79], v248, s[24:27], s75 offen sc1
    v_mfma_f32_16x16x32_bf16 v[236:239], v[204:207], v[36:39], v[236:239]
    v_mfma_f32_16x16x32_bf16 v[240:243], v[208:211], v[36:39], v[240:243]
    v_mfma_f32_16x16x32_bf16 v[244:247], v[212:215], v[36:39], v[244:247]
    s_waitcnt lgkmcnt(6)
    v_mfma_f32_16x16x32_bf16 v[232:235], v[216:219], v[40:43], v[232:235]
    s_waitcnt lgkmcnt(4)
    v_mfma_f32_16x16x32_bf16 v[236:239], v[220:223], v[40:43], v[236:239]
    s_waitcnt vmcnt(6)
    v_max3_u32 v249, v48, v48, v52
    s_waitcnt lgkmcnt(2)
    v_mfma_f32_16x16x32_bf16 v[240:243], v[224:227], v[40:43], v[240:243]
    v_cmp_eq_u32 vcc, -1, v249
    s_waitcnt lgkmcnt(0)
    v_mfma_f32_16x16x32_bf16 v[244:247], v[228:231], v[40:43], v[244:247]
    s_cbranch_vccnz L_Bk10r
L_Bk10d:

    s_cmp_ge_u32 s3, 4
    s_cbranch_scc1 L_Bf0
    v_mfma_f32_16x16x32_bf16 v[0:3], v[88:91], v[44:47], 0
    ds_write_b128 v250, v[232:235] offset:0
    v_mfma_f32_16x16x32_bf16 v[4:7], v[92:95], v[44:47], 0
    v_mfma_f32_16x16x32_bf16 v[80:83], v[96:99], v[44:47], 0
    ds_write_b128 v250, v[236:239] offset:1024
    v_mfma_f32_16x16x32_bf16 v[84:87], v[100:103], v[44:47], 0
    v_mfma_f32_16x16x32_bf16 v[0:3], v[104:107], v[48:51], v[0:3]
    ds_write_b128 v250, v[240:243] offset:2048
    v_mfma_f32_16x16x32_bf16 v[4:7], v[108:111], v[48:51], v[4:7]
    v_mfma_f32_16x16x32_bf16 v[80:83], v[112:115], v[48:51], v[80:83]
    ds_write_b128 v250, v[244:247] offset:3072
    v_mfma_f32_16x16x32_bf16 v[84:87], v[116:119], v[48:51], v[84:87]
    v_mfma_f32_16x16x32_bf16 v[0:3], v[120:123], v[52:55], v[0:3]
    v_mfma_f32_16x16x32_bf16 v[4:7], v[124:127], v[52:55], v[4:7]
    s_waitcnt vmcnt(3)
    v_max3_u32 v249, v56, v60, v64
    v_mfma_f32_16x16x32_bf16 v[80:83], v[128:131], v[52:55], v[80:83]
    v_cmp_eq_u32 vcc, -1, v249
    s_waitcnt lgkmcnt(0)
    s_barrier
    v_mfma_f32_16x16x32_bf16 v[84:87], v[132:135], v[52:55], v[84:87]
    s_cbranch_vccnz L_Bk11cr
L_Bk11cd:
    ds_read_b128 v[16:19], v251 offset:0
    v_mfma_f32_16x16x32_bf16 v[0:3], v[136:139], v[56:59], v[0:3]
    ds_read_b128 v[20:23], v251 offset:1024
    v_mfma_f32_16x16x32_bf16 v[4:7], v[140:143], v[56:59], v[4:7]
    ds_read_b128 v[24:27], v251 offset:2048
    v_mfma_f32_16x16x32_bf16 v[80:83], v[144:147], v[56:59], v[80:83]
    ds_read_b128 v[28:31], v251 offset:3072
    v_mfma_f32_16x16x32_bf16 v[84:87], v[148:151], v[56:59], v[84:87]
    v_mfma_f32_16x16x32_bf16 v[0:3], v[152:155], v[60:63], v[0:3]
    v_mfma_f32_16x16x32_bf16 v[4:7], v[156:159], v[60:63], v[4:7]
    v_mfma_f32_16x16x32_bf16 v[80:83], v[160:163], v[60:63], v[80:83]
    v_mfma_f32_16x16x32_bf16 v[84:87], v[164:167], v[60:63], v[84:87]
    v_mfma_f32_16x16x32_bf16 v[0:3], v[168:171], v[64:67], v[0:3]
    v_mfma_f32_16x16x32_bf16 v[4:7], v[172:175], v[64:67], v[4:7]
    s_waitcnt vmcnt(0)
    v_max3_u32 v249, v68, v72, v76
    v_mfma_f32_16x16x32_bf16 v[80:83], v[176:179], v[64:67], v[80:83]
    v_cmp_eq_u32 vcc, -1, v249
    v_mfma_f32_16x16x32_bf16 v[84:87], v[180:183], v[64:67], v[84:87]
    s_cbranch_vccnz L_Bk12cr
L_Bk12cd:
    v_mfma_f32_16x16x32_bf16 v[0:3], v[184:187], v[68:71], v[0:3]
    v_mfma_f32_16x16x32_bf16 v[4:7], v[188:191], v[68:71], v[4:7]
    v_mfma_f32_16x16x32_bf16 v[80:83], v[192:195], v[68:71], v[80:83]
    v_mfma_f32_16x16x32_bf16 v[84:87], v[196:199], v[68:71], v[84:87]
    v_mfma_f32_16x16x32_bf16 v[0:3], v[200:203], v[72:75], v[0:3]
    v_mfma_f32_16x16x32_bf16 v[4:7], v[204:207], v[72:75], v[4:7]
    v_mfma_f32_16x16x32_bf16 v[80:83], v[208:211], v[72:75], v[80:83]
    v_mfma_f32_16x16x32_bf16 v[84:87], v[212:215], v[72:75], v[84:87]
    v_mfma_f32_16x16x32_bf16 v[0:3], v[216:219], v[76:79], v[0:3]
    v_mfma_f32_16x16x32_bf16 v[4:7], v[220:223], v[76:79], v[4:7]
    v_mfma_f32_16x16x32_bf16 v[80:83], v[224:227], v[76:79], v[80:83]
    v_mfma_f32_16x16x32_bf16 v[84:87], v[228:231], v[76:79], v[84:87]
    s_waitcnt lgkmcnt(0)
    s_nop 3
    v_add_f32 v16, v16, v0
    v_add_f32 v17, v17, v1
    v_add_f32 v18, v18, v2
    v_add_f32 v19, v19, v3
    v_cvt_pk_bf16_f32 v16, v16, v17
    v_cvt_pk_bf16_f32 v17, v18, v19
    ds_write_b64 v252, v[16:17] offset:0
    v_add_f32 v20, v20, v4
    v_add_f32 v21, v21, v5
    v_add_f32 v22, v22, v6
    v_add_f32 v23, v23, v7
    v_cvt_pk_bf16_f32 v20, v20, v21
    v_cvt_pk_bf16_f32 v21, v22, v23
    ds_write_b64 v252, v[20:21] offset:32
    v_add_f32 v24, v24, v80
    v_add_f32 v25, v25, v81
    v_add_f32 v26, v26, v82
    v_add_f32 v27, v27, v83
    v_cvt_pk_bf16_f32 v24, v24, v25
    v_cvt_pk_bf16_f32 v25, v26, v27
    ds_write_b64 v252, v[24:25] offset:64
    v_add_f32 v28, v28, v84
    v_add_f32 v29, v29, v85
    v_add_f32 v30, v30, v86
    v_add_f32 v31, v31, v87
    v_cvt_pk_bf16_f32 v28, v28, v29
    v_cvt_pk_bf16_f32 v29, v30, v31
    ds_write_b64 v252, v[28:29] offset:96
    s_branch L_Bf1
L_Bf0:
    v_mfma_f32_16x16x32_bf16 v[0:3], v[88:91], v[44:47], 0
    v_mfma_f32_16x16x32_bf16 v[4:7], v[92:95], v[44:47], 0
    v_mfma_f32_16x16x32_bf16 v[80:83], v[96:99], v[44:47], 0
    v_mfma_f32_16x16x32_bf16 v[84:87], v[100:103], v[44:47], 0
    v_mfma_f32_16x16x32_bf16 v[0:3], v[104:107], v[48:51], v[0:3]
    v_mfma_f32_16x16x32_bf16 v[4:7], v[108:111], v[48:51], v[4:7]
    v_mfma_f32_16x16x32_bf16 v[80:83], v[112:115], v[48:51], v[80:83]
    v_mfma_f32_16x16x32_bf16 v[84:87], v[116:119], v[48:51], v[84:87]
    v_mfma_f32_16x16x32_bf16 v[0:3], v[120:123], v[52:55], v[0:3]
    v_mfma_f32_16x16x32_bf16 v[4:7], v[124:127], v[52:55], v[4:7]
    s_waitcnt vmcnt(3)
    v_max3_u32 v249, v56, v60, v64
    v_mfma_f32_16x16x32_bf16 v[80:83], v[128:131], v[52:55], v[80:83]
    v_cmp_eq_u32 vcc, -1, v249
    v_mfma_f32_16x16x32_bf16 v[84:87], v[132:135], v[52:55], v[84:87]
    s_cbranch_vccnz L_Bk11hr
L_Bk11hd:
    v_mfma_f32_16x16x32_bf16 v[0:3], v[136:139], v[56:59], v[0:3]
    v_mfma_f32_16x16x32_bf16 v[4:7], v[140:143], v[56:59], v[4:7]
    v_mfma_f32_16x16x32_bf16 v[80:83], v[144:147], v[56:59], v[80:83]
    v_mfma_f32_16x16x32_bf16 v[84:87], v[148:151], v[56:59], v[84:87]
    v_mfma_f32_16x16x32_bf16 v[0:3], v[152:155], v[60:63], v[0:3]
    v_mfma_f32_16x16x32_bf16 v[4:7], v[156:159], v[60:63], v[4:7]
    v_mfma_f32_16x16x32_bf16 v[80:83], v[160:163], v[60:63], v[80:83]
    v_mfma_f32_16x16x32_bf16 v[84:87], v[164:167], v[60:63], v[84:87]
    v_mfma_f32_16x16x32_bf16 v[0:3], v[168:171], v[64:67], v[0:3]
    v_mfma_f32_16x16x32_bf16 v[4:7], v[172:175], v[64:67], v[4:7]
    s_waitcnt vmcnt(0)
    v_max3_u32 v249, v68, v72, v76
    v_mfma_f32_16x16x32_bf16 v[80:83], v[176:179], v[64:67], v[80:83]
    v_cmp_eq_u32 vcc, -1, v249
    v_mfma_f32_16x16x32_bf16 v[84:87], v[180:183], v[64:67], v[84:87]
    s_cbranch_vccnz L_Bk12hr
L_Bk12hd:
    v_mfma_f32_16x16x32_bf16 v[0:3], v[184:187], v[68:71], v[0:3]
    v_mfma_f32_16x16x32_bf16 v[4:7], v[188:191], v[68:71], v[4:7]
    v_mfma_f32_16x16x32_bf16 v[80:83], v[192:195], v[68:71], v[80:83]
    v_mfma_f32_16x16x32_bf16 v[84:87], v[196:199], v[68:71], v[84:87]
    v_mfma_f32_16x16x32_bf16 v[0:3], v[200:203], v[72:75], v[0:3]
    v_mfma_f32_16x16x32_bf16 v[4:7], v[204:207], v[72:75], v[4:7]
    v_mfma_f32_16x16x32_bf16 v[80:83], v[208:211], v[72:75], v[80:83]
    v_mfma_f32_16x16x32_bf16 v[84:87], v[212:215], v[72:75], v[84:87]
    v_mfma_f32_16x16x32_bf16 v[0:3], v[216:219], v[76:79], v[0:3]
    v_mfma_f32_16x16x32_bf16 v[4:7], v[220:223], v[76:79], v[4:7]
    v_mfma_f32_16x16x32_bf16 v[80:83], v[224:227], v[76:79], v[80:83]
    v_mfma_f32_16x16x32_bf16 v[84:87], v[228:231], v[76:79], v[84:87]

    s_nop 4
    ds_write_b128 v250, v[0:3] offset:0
    ds_write_b128 v250, v[4:7] offset:1024
    ds_write_b128 v250, v[80:83] offset:2048
    ds_write_b128 v250, v[84:87] offset:3072
    s_waitcnt lgkmcnt(0)
    s_barrier
    ds_read_b128 v[16:19], v251 offset:0
    ds_read_b128 v[20:23], v251 offset:1024
    ds_read_b128 v[24:27], v251 offset:2048
    ds_read_b128 v[28:31], v251 offset:3072
    s_waitcnt lgkmcnt(0)
    v_add_f32 v16, v16, v232
    v_add_f32 v17, v17, v233
    v_add_f32 v18, v18, v234
    v_add_f32 v19, v19, v235
    v_cvt_pk_bf16_f32 v16, v16, v17
    v_cvt_pk_bf16_f32 v17, v18, v19
    ds_write_b64 v252, v[16:17] offset:0
    v_add_f32 v20, v20, v236
    v_add_f32 v21, v21, v237
    v_add_f32 v22, v22, v238
    v_add_f32 v23, v23, v239
    v_cvt_pk_bf16_f32 v20, v20, v21
    v_cvt_pk_bf16_f32 v21, v22, v23
    ds_write_b64 v252, v[20:21] offset:32
    v_add_f32 v24, v24, v240
    v_add_f32 v25, v25, v241
    v_add_f32 v26, v26, v242
    v_add_f32 v27, v27, v243
    v_cvt_pk_bf16_f32 v24, v24, v25
    v_cvt_pk_bf16_f32 v25, v26, v27
    ds_write_b64 v252, v[24:25] offset:64
    v_add_f32 v28, v28, v244
    v_add_f32 v29, v29, v245
    v_add_f32 v30, v30, v246
    v_add_f32 v31, v31, v247
    v_cvt_pk_bf16_f32 v28, v28, v29
    v_cvt_pk_bf16_f32 v29, v30, v31
    ds_write_b64 v252, v[28:29] offset:96
L_Bf1:
    s_waitcnt lgkmcnt(0)
    ds_read_b128 v[8:11], v253
    ds_read_b128 v[12:15], v253 offset:1152
    s_add_u32 s4, s73, 36864
    s_waitcnt lgkmcnt(1)
    buffer_store_dwordx4 v[8:11], v254, s[20:23], s73 offen sc0 sc1
    s_waitcnt lgkmcnt(0)
    buffer_store_dwordx4 v[12:15], v254, s[20:23], s4 offen sc0 sc1
    s_endpgm
L_Bk00r:
    s_sub_u32 s5, s5, 1
    s_cmp_lt_i32 s5, 0
    s_cbranch_scc1 L_Bk00d
    buffer_load_dwordx4 v[12:15], v248, s[12:15], s57 offen sc1
    buffer_load_dwordx4 v[16:19], v248, s[12:15], s58 offen sc1
    buffer_load_dwordx4 v[20:23], v248, s[12:15], s59 offen sc1
    buffer_load_dwordx4 v[24:27], v248, s[12:15], s60 offen sc1
    buffer_load_dwordx4 v[28:31], v248, s[12:15], s61 offen sc1
    buffer_load_dwordx4 v[32:35], v248, s[12:15], s62 offen sc1
    buffer_load_dwordx4 v[36:39], v248, s[12:15], s63 offen sc1
    buffer_load_dwordx4 v[40:43], v248, s[12:15], s75 offen sc1
    s_waitcnt vmcnt(0)
    v_max3_u32 v249, v12, v12, v16
    v_cmp_eq_u32 vcc, -1, v249
    s_cbranch_vccnz L_Bk00r
    s_branch L_Bk00d
L_Bk01r:
    s_sub_u32 s5, s5, 1
    s_cmp_lt_i32 s5, 0
    s_cbranch_scc1 L_Bk01d
    buffer_load_dwordx4 v[20:23], v248, s[12:15], s59 offen sc1
    buffer_load_dwordx4 v[24:27], v248, s[12:15], s60 offen sc1
    buffer_load_dwordx4 v[28:31], v248, s[12:15], s61 offen sc1
    buffer_load_dwordx4 v[32:35], v248, s[12:15], s62 offen sc1
    buffer_load_dwordx4 v[36:39], v248, s[12:15], s63 offen sc1
    buffer_load_dwordx4 v[40:43], v248, s[12:15], s75 offen sc1
    s_waitcnt vmcnt(0)
    v_max3_u32 v249, v20, v24, v28
    v_cmp_eq_u32 vcc, -1, v249
    s_cbranch_vccnz L_Bk01r
    s_branch L_Bk01d
L_Bk02r:
    s_sub_u32 s5, s5, 1
    s_cmp_lt_i32 s5, 0
    s_cbranch_scc1 L_Bk02d
    buffer_load_dwordx4 v[32:35], v248, s[12:15], s62 offen sc1
    buffer_load_dwordx4 v[36:39], v248, s[12:15], s63 offen sc1
    buffer_load_dwordx4 v[40:43], v248, s[12:15], s75 offen sc1
    s_waitcnt vmcnt(0)
    v_max3_u32 v249, v32, v36, v40
    v_cmp_eq_u32 vcc, -1, v249
    s_cbranch_vccnz L_Bk02r
    s_branch L_Bk02d
L_Bk10r:
    s_sub_u32 s5, s5, 1
    s_cmp_lt_i32 s5, 0
    s_cbranch_scc1 L_Bk10d
    buffer_load_dwordx4 v[48:51], v248, s[24:27], s57 offen sc1
    buffer_load_dwordx4 v[52:55], v248, s[24:27], s58 offen sc1
    buffer_load_dwordx4 v[56:59], v248, s[24:27], s59 offen sc1
    buffer_load_dwordx4 v[60:63], v248, s[24:27], s60 offen sc1
    buffer_load_dwordx4 v[64:67], v248, s[24:27], s61 offen sc1
    buffer_load_dwordx4 v[68:71], v248, s[24:27], s62 offen sc1
    buffer_load_dwordx4 v[72:75], v248, s[24:27], s63 offen sc1
    buffer_load_dwordx4 v[76:79], v248, s[24:27], s75 offen sc1
    s_waitcnt vmcnt(6)
    v_max3_u32 v249, v48, v48, v52
    v_cmp_eq_u32 vcc, -1, v249
    s_cbranch_vccnz L_Bk10r
    s_branch L_Bk10d
L_Bk11cr:
    s_sub_u32 s5, s5, 1
    s_cmp_lt_i32 s5, 0
    s_cbranch_scc1 L_Bk11cd
    buffer_load_dwordx4 v[56:59], v248, s[24:27], s59 offen sc1
    buffer_load_dwordx4 v[60:63], v248, s[24:27], s60 offen sc1
    buffer_load_dwordx4 v[64:67], v248, s[24:27], s61 offen sc1
    buffer_load_dwordx4 v[68:71], v248, s[24:27], s62 offen sc1
    buffer_load_dwordx4 v[72:75], v248, s[24:27], s63 offen sc1
    buffer_load_dwordx4 v[76:79], v248, s[24:27], s75 offen sc1
    s_waitcnt vmcnt(3)
    v_max3_u32 v249, v56, v60, v64
    v_cmp_eq_u32 vcc, -1, v249
    s_cbranch_vccnz L_Bk11cr
    s_branch L_Bk11cd
L_Bk12cr:
    s_sub_u32 s5, s5, 1
    s_cmp_lt_i32 s5, 0
    s_cbranch_scc1 L_Bk12cd
    buffer_load_dwordx4 v[68:71], v248, s[24:27], s62 offen sc1
    buffer_load_dwordx4 v[72:75], v248, s[24:27], s63 offen sc1
    buffer_load_dwordx4 v[76:79], v248, s[24:27], s75 offen sc1
    s_waitcnt vmcnt(0)
    v_max3_u32 v249, v68, v72, v76
    v_cmp_eq_u32 vcc, -1, v249
    s_cbranch_vccnz L_Bk12cr
    s_branch L_Bk12cd
L_Bk11hr:
    s_sub_u32 s5, s5, 1
    s_cmp_lt_i32 s5, 0
    s_cbranch_scc1 L_Bk11hd
    buffer_load_dwordx4 v[56:59], v248, s[24:27], s59 offen sc1
    buffer_load_dwordx4 v[60:63], v248, s[24:27], s60 offen sc1
    buffer_load_dwordx4 v[64:67], v248, s[24:27], s61 offen sc1
    buffer_load_dwordx4 v[68:71], v248, s[24:27], s62 offen sc1
    buffer_load_dwordx4 v[72:75], v248, s[24:27], s63 offen sc1
    buffer_load_dwordx4 v[76:79], v248, s[24:27], s75 offen sc1
    s_waitcnt vmcnt(3)
    v_max3_u32 v249, v56, v60, v64
    v_cmp_eq_u32 vcc, -1, v249
    s_cbranch_vccnz L_Bk11hr
    s_branch L_Bk11hd
L_Bk12hr:
    s_sub_u32 s5, s5, 1
    s_cmp_lt_i32 s5, 0
    s_cbranch_scc1 L_Bk12hd
    buffer_load_dwordx4 v[68:71], v248, s[24:27], s62 offen sc1
    buffer_load_dwordx4 v[72:75], v248, s[24:27], s63 offen sc1
    buffer_load_dwordx4 v[76:79], v248, s[24:27], s75 offen sc1
    s_waitcnt vmcnt(0)
    v_max3_u32 v249, v68, v72, v76
    v_cmp_eq_u32 vcc, -1, v249
    s_cbranch_vccnz L_Bk12hr
    s_branch L_Bk12hd
L_A:
    s_cmp_lt_u32 s33, 30
    s_cbranch_scc1 L_A0

    s_lshl_b32 s6, s3, 4
    s_sub_u32 s7, s2, 240
    s_add_u32 s6, s6, s7
    s_add_u32 s50, s6, 192
    v_mul_u32_u24 v4, 3456, v0
    v_lshlrev_b32 v1, 7, v0
    s_lshl_b32 s7, s6, 13
    s_waitcnt lgkmcnt(0)
L_P1:
    buffer_load_dword v2, v1, s[16:19], s7 offen
    s_endpgm
L_A0:
    s_sub_u32 s33, s33, 18
    s_mul_i32 s40, s32, 6
    s_add_u32 s40, s40, s33
    s_cmp_ge_u32 s33, 6
    s_cselect_b32 s6, 6, 0
    s_addc_u32 s32, s32, 0
    s_sub_u32 s33, s33, s6
    s_mul_i32 s34, s33, 3
    s_lshr_b32 s34, s34, 1
    s_mul_i32 s34, s34, 1
    s_cmp_lt_u32 s3, 4
    s_cbranch_scc1 L_Ac
    s_sub_u32 s39, s3, 4
    v_and_b32 v1, 7, v0
    v_lshlrev_b32 v1, 4, v1
    v_bfe_u32 v2, v0, 3, 1
    v_bfe_u32 v3, v0, 4, 1
    v_lshrrev_b32 v4, 5, v0
    v_lshl_add_u32 v2, v3, 4, v2
    v_lshl_add_u32 v2, v4, 2, v2
    s_and_b32 s6, s39, 1
    s_lshl_b32 s6, s6, 1
    s_lshr_b32 s7, s39, 1
    s_lshl_b32 s7, s7, 3
    s_add_u32 s6, s6, s7
    v_add_u32 v2, s6, v2
    v_mul_u32_u24 v2, 36864, v2
    v_add_u32 v2, v2, v1
    s_mul_i32 s63, s32, 2304
    s_mul_i32 s64, s39, 1056
    s_mov_b32 s66, 0
    s_waitcnt lgkmcnt(0)

    s_mov_b32 s8, s4
    s_mov_b32 s9, s5
L_Ald:
    s_lshl_b32 s68, s34, 7
    s_add_u32 s68, s68, s63
    s_add_u32 m0, s64, 0
    s_add_u32 s7, s68, 0
    buffer_load_dwordx4 v2, s[8:11], s7 offen  lds
    s_add_u32 m0, s64, 4224
    s_add_u32 s7, s68, 1179648
    buffer_load_dwordx4 v2, s[8:11], s7 offen  lds
    s_add_u32 m0, s64, 8448
    s_add_u32 s7, s68, 1152
    buffer_load_dwordx4 v2, s[8:11], s7 offen  lds
    s_add_u32 m0, s64, 12672
    s_add_u32 s7, s68, 1180800
    buffer_load_dwordx4 v2, s[8:11], s7 offen  lds
    s_add_u32 s34, s34, 1
    s_cmp_eq_u32 s34, 9
    s_cselect_b32 s34, 0, s34
    s_add_u32 s64, s64, 16896
    s_add_u32 s66, s66, 1
    s_cmp_lt_u32 s66, 9
    s_cbranch_scc1 L_Ald
    v_lshlrev_b32 v5, 4, v0
    v_mov_b32 v8, -1
    v_mov_b32 v9, -1
    v_mov_b32 v10, -1
    v_mov_b32 v11, -1
    s_mul_i32 s6, s40, 24576
    s_mul_i32 s7, s39, 6144
    s_add_u32 s6, s6, s7
    v_lshrrev_b32 v6, 4, v0
    v_mul_u32_u24 v6, 147456, v6
    v_and_b32 v7, 0xf0, v5
    v_add_u32 v6, v6, v7
    s_mul_i32 s50, s40, 768
    s_mul_i32 s7, s39, 589824
    s_add_u32 s50, s50, s7
    s_waitcnt vmcnt(32)
    s_barrier
    s_add_u32 s7, s6, 8388608
    buffer_store_dwordx4 v[8:11], v5, s[24:27], s7 offen offset:0 sc1
    s_add_u32 s7, s6, 8388608
    buffer_store_dwordx4 v[8:11], v5, s[24:27], s7 offen offset:1024 sc1
    s_add_u32 s7, s6, 8388608
    buffer_store_dwordx4 v[8:11], v5, s[24:27], s7 offen offset:2048 sc1
    s_waitcnt vmcnt(31)
    s_barrier
    s_add_u32 s7, s6, 8391680
    buffer_store_dwordx4 v[8:11], v5, s[24:27], s7 offen offset:0 sc1
    s_add_u32 s7, s6, 8391680
    buffer_store_dwordx4 v[8:11], v5, s[24:27], s7 offen offset:1024 sc1
    s_add_u32 s7, s6, 8391680
    buffer_store_dwordx4 v[8:11], v5, s[24:27], s7 offen offset:2048 sc1
    buffer_load_dword v12, off, s[28:31], 0 sc1
    s_waitcnt vmcnt(31)
    s_barrier
    s_add_u32 s7, s6, 4194304
    buffer_store_dwordx4 v[8:11], v5, s[24:27], s7 offen offset:0 sc1
    s_add_u32 s7, s6, 4194304
    buffer_store_dwordx4 v[8:11], v5, s[24:27], s7 offen offset:1024 sc1
    s_add_u32 s7, s6, 4194304
    buffer_store_dwordx4 v[8:11], v5, s[24:27], s7 offen offset:2048 sc1
    s_waitcnt vmcnt(30)
    s_barrier
    s_add_u32 s7, s6, 4197376
    buffer_store_dwordx4 v[8:11], v5, s[24:27], s7 offen offset:0 sc1
    s_add_u32 s7, s6, 4197376
    buffer_store_dwordx4 v[8:11], v5, s[24:27], s7 offen offset:1024 sc1
    s_add_u32 s7, s6, 4197376
    buffer_store_dwordx4 v[8:11], v5, s[24:27], s7 offen offset:2048 sc1
    s_waitcnt vmcnt(6)
    s_barrier
    s_cmp_lg_u32 s3, 4
    s_cbranch_scc1 L_Ald5
    s_movk_i32 s5, 3750
L_Ald3b:
    v_cmp_le_i32 vcc, 0, v12
    s_cbranch_vccz L_Ald4b
    s_sleep 8
    buffer_load_dword v12, off, s[28:31], 0 sc1
    s_sub_u32 s5, s5, 1
    s_waitcnt vmcnt(0)
    s_cbranch_scc0 L_Ald3b
L_Ald4b:
    s_lshl_b32 s51, s40, 7
    s_add_u32 s51, s51, 12582912
    v_mov_b32 v13, v12
    v_mov_b32 v14, v12
    v_mov_b32 v15, v12
    s_mov_b64 exec, 0xff
    buffer_store_dwordx4 v[12:15], v5, s[24:27], s51 offen sc1
    s_mov_b64 exec, -1
L_Ald5:
    s_add_u32 s7, s50, 0
    buffer_store_dwordx4 v[8:11], v6, s[24:27], s7 offen offset:0 sc1
    s_add_u32 s7, s50, 0
    buffer_store_dwordx4 v[8:11], v6, s[24:27], s7 offen offset:256 sc1
    s_add_u32 s7, s50, 0
    buffer_store_dwordx4 v[8:11], v6, s[24:27], s7 offen offset:512 sc1
    s_barrier
    s_add_u32 s7, s50, 73728
    buffer_store_dwordx4 v[8:11], v6, s[24:27], s7 offen offset:0 sc1
    s_add_u32 s7, s50, 73728
    buffer_store_dwordx4 v[8:11], v6, s[24:27], s7 offen offset:256 sc1
    s_add_u32 s7, s50, 73728
    buffer_store_dwordx4 v[8:11], v6, s[24:27], s7 offen offset:512 sc1
    s_barrier
    s_waitcnt vmcnt(0)
    s_barrier
    s_cmp_lg_u32 s3, 4
    s_cbranch_scc1 L_end
    s_movk_i32 s5, 3750
L_Ald3:
    v_cmp_le_i32 vcc, 0, v12
    s_cbranch_vccz L_Ald4
    s_sleep 8
    buffer_load_dword v12, off, s[28:31], 0 sc1
    s_sub_u32 s5, s5, 1
    s_waitcnt vmcnt(0)
    s_cbranch_scc0 L_Ald3
L_Ald4:
    s_lshl_b32 s51, s40, 7
    s_add_u32 s51, s51, 12599296
    v_mov_b32 v13, v12
    v_mov_b32 v14, v12
    v_mov_b32 v15, v12
    s_mov_b64 exec, 0xff
    buffer_store_dwordx4 v[12:15], v5, s[24:27], s51 offen sc1
    s_barrier
    s_endpgm
L_Ac:
    s_getpc_b64 s[36:37]
L_pc1:
    s_sub_u32 s36, s36, L_pc1-L_top
    s_subb_u32 s37, s37, 0
    s_lshl_b32 s38, s3, 13
    v_lshl_add_u32 v250, v0, 7, s38
    v_min_u32 v250, L_last-L_top, v250
    global_load_dword v251, v250, s[36:37]
    s_cmp_lg_u32 s3, 3
    s_cbranch_scc1 L_Ac0

    s_lshr_b32 s6, s2, 3
    s_sub_u32 s6, s6, 18
    s_mul_i32 s6, s6, 55296
    v_lshlrev_b32 v1, 7, v0
    s_waitcnt lgkmcnt(0)
    v_mul_u32_u24 v3, 1152, v0
    s_lshr_b32 s54, s2, 3
    s_sub_u32 s54, s54, 18
    s_and_b32 s53, s2, 7
    s_and_b32 s52, s54, 3
    s_lshl_b32 s53, s53, 2
    s_add_u32 s52, s52, s53
    s_lshl_b32 s53, s52, 13
    s_mul_i32 s52, s52, 73728
    s_lshr_b32 s54, s54, 2
    s_add_u32 s54, s54, 2
    s_lshr_b32 s50, s54, 1
    s_bitcmp0_b32 s54, 0
    s_cbranch_scc1 L_Au0
    s_lshl_b32 s50, s50, 7
    s_add_u32 s50, s50, s52

    buffer_load_dword v2, v3, s[8:11], s50 offen
    s_branch L_Av0
L_Au0:
    s_mul_i32 s50, s50, 221184
    s_add_u32 s50, s50, s53
    buffer_load_dword v2, v1, s[12:15], s50 offen
L_Av0:
    s_add_u32 s54, s54, 3
    s_lshr_b32 s50, s54, 1
    s_bitcmp0_b32 s54, 0
    s_cbranch_scc1 L_Au1
    s_lshl_b32 s50, s50, 7
    s_add_u32 s50, s50, s52

    buffer_load_dword v2, v3, s[8:11], s50 offen
    s_branch L_Av1
L_Au1:
    s_mul_i32 s50, s50, 221184
    s_add_u32 s50, s50, s53
    buffer_load_dword v2, v1, s[12:15], s50 offen
L_Av1:
    s_add_u32 s54, s54, 3
    s_lshr_b32 s50, s54, 1
    s_bitcmp0_b32 s54, 0
    s_cbranch_scc1 L_Au2
    s_lshl_b32 s50, s50, 7
    s_add_u32 s50, s50, s52

    buffer_load_dword v2, v3, s[8:11], s50 offen
    s_branch L_Av2
L_Au2:
    s_mul_i32 s50, s50, 221184
    s_add_u32 s50, s50, s53
    buffer_load_dword v2, v1, s[12:15], s50 offen
L_Av2:
    s_add_u32 s54, s54, 3
    s_lshr_b32 s50, s54, 1
    s_bitcmp0_b32 s54, 0
    s_cbranch_scc1 L_Au3
    s_lshl_b32 s50, s50, 7
    s_add_u32 s50, s50, s52

    buffer_load_dword v2, v3, s[8:11], s50 offen
    s_branch L_Av3
L_Au3:
    s_mul_i32 s50, s50, 221184
    s_add_u32 s50, s50, s53
    buffer_load_dword v2, v1, s[12:15], s50 offen
L_Av3:
    s_add_u32 s54, s54, 3
    s_lshr_b32 s50, s54, 1
    s_bitcmp0_b32 s54, 0
    s_cbranch_scc1 L_Au4
    s_lshl_b32 s50, s50, 7
    s_add_u32 s50, s50, s52

    buffer_load_dword v2, v3, s[8:11], s50 offen
    s_branch L_Av4
L_Au4:
    s_mul_i32 s50, s50, 221184
    s_add_u32 s50, s50, s53
    buffer_load_dword v2, v1, s[12:15], s50 offen
L_Av4:
    s_add_u32 s54, s54, 3
    s_lshr_b32 s50, s54, 1
    s_bitcmp0_b32 s54, 0
    s_cbranch_scc1 L_Au5
    s_lshl_b32 s50, s50, 7
    s_add_u32 s50, s50, s52
    s_cmp_gt_u32 s54, 17
    s_cbranch_scc1 L_Av5
    buffer_load_dword v2, v3, s[8:11], s50 offen
    s_branch L_Av5
L_Au5:
    s_mul_i32 s50, s50, 221184
    s_add_u32 s50, s50, s53
    buffer_load_dword v2, v1, s[12:15], s50 offen
L_Av5:
    s_add_u32 s54, s54, 3
    s_endpgm
L_Ac0:
    v_and_b32 v240, 15, v0
    v_lshrrev_b32 v241, 4, v0
    s_mul_i32 s41, s33, 3
    s_add_u32 s41, s41, s3
    s_lshl_b32 s6, s41, 4
    v_add_u32 v242, s6, v240
    v_mul_u32_u24 v243, 911, v242
    v_lshrrev_b32 v243, 16, v243
    v_mul_u32_u24 v244, 287, v243
    v_lshlrev_b32 v245, 2, v242
    v_sub_u32 v244, v245, v244
    v_cvt_f32_u32 v245, v244
    v_mul_f32 v245, 0x3ae38e39, v245
    v_and_b32 v246, 1, v244
    v_mul_u32_u24 v246, 0x8000, v246
    v_lshl_or_b32 v246, v246, 16, v246
    s_lshl_b32 s6, s34, 6
    v_lshl_add_u32 v247, v241, 3, s6
    v_cvt_f32_u32 v247, v247
    v_mul_f32 v144, v247, v245
    v_add_f32 v247, 0x42000000, v247
    v_fract_f32 v144, v144
    v_add_f32 v145, v144, v245
    v_add_f32 v146, v145, v245
    v_add_f32 v147, v146, v245
    v_add_f32 v148, v147, v245
    v_add_f32 v149, v148, v245
    v_add_f32 v150, v149, v245
    v_add_f32 v151, v150, v245
    v_cos_f32 v152, v144
    v_cos_f32 v153, v145
    v_cos_f32 v154, v146
    v_cos_f32 v155, v147
    v_cos_f32 v156, v148
    v_cos_f32 v157, v149
    v_cos_f32 v158, v150
    v_cos_f32 v159, v151
    v_sin_f32 v144, -v144
    v_sin_f32 v145, -v145
    v_sin_f32 v146, -v146
    v_sin_f32 v147, -v147
    v_sin_f32 v148, -v148
    v_sin_f32 v149, -v149
    v_sin_f32 v150, -v150
    v_sin_f32 v151, -v151
    v_cvt_pk_bf16_f32 v72, v152, v153
    v_cvt_pk_bf16_f32 v73, v154, v155
    v_cvt_pk_bf16_f32 v74, v156, v157
    v_cvt_pk_bf16_f32 v75, v158, v159
    v_cvt_pk_bf16_f32 v76, v144, v145
    v_cvt_pk_bf16_f32 v77, v146, v147
    v_cvt_pk_bf16_f32 v78, v148, v149
    v_cvt_pk_bf16_f32 v79, v150, v151
    v_mul_f32 v144, v247, v245
    v_add_f32 v247, 0x42000000, v247
    v_fract_f32 v144, v144
    v_add_f32 v145, v144, v245
    v_add_f32 v146, v145, v245
    v_add_f32 v147, v146, v245
    v_add_f32 v148, v147, v245
    v_add_f32 v149, v148, v245
    v_add_f32 v150, v149, v245
    v_add_f32 v151, v150, v245
    v_cos_f32 v152, v144
    v_cos_f32 v153, v145
    v_cos_f32 v154, v146
    v_cos_f32 v155, v147
    v_cos_f32 v156, v148
    v_cos_f32 v157, v149
    v_cos_f32 v158, v150
    v_cos_f32 v159, v151
    v_sin_f32 v144, -v144
    v_sin_f32 v145, -v145
    v_sin_f32 v146, -v146
    v_sin_f32 v147, -v147
    v_sin_f32 v148, -v148
    v_sin_f32 v149, -v149
    v_sin_f32 v150, -v150
    v_sin_f32 v151, -v151
    v_cvt_pk_bf16_f32 v80, v152, v153
    v_cvt_pk_bf16_f32 v81, v154, v155
    v_cvt_pk_bf16_f32 v82, v156, v157
    v_cvt_pk_bf16_f32 v83, v158, v159
    v_cvt_pk_bf16_f32 v84, v144, v145
    v_cvt_pk_bf16_f32 v85, v146, v147
    v_cvt_pk_bf16_f32 v86, v148, v149
    v_cvt_pk_bf16_f32 v87, v150, v151
    v_mul_f32 v144, v247, v245
    v_add_f32 v247, 0x42000000, v247
    v_fract_f32 v144, v144
    v_add_f32 v145, v144, v245
    v_add_f32 v146, v145, v245
    v_add_f32 v147, v146, v245
    v_add_f32 v148, v147, v245
    v_add_f32 v149, v148, v245
    v_add_f32 v150, v149, v245
    v_add_f32 v151, v150, v245
    v_cos_f32 v152, v144
    v_cos_f32 v153, v145
    v_cos_f32 v154, v146
    v_cos_f32 v155, v147
    v_cos_f32 v156, v148
    v_cos_f32 v157, v149
    v_cos_f32 v158, v150
    v_cos_f32 v159, v151
    v_sin_f32 v144, -v144
    v_sin_f32 v145, -v145
    v_sin_f32 v146, -v146
    v_sin_f32 v147, -v147
    v_sin_f32 v148, -v148
    v_sin_f32 v149, -v149
    v_sin_f32 v150, -v150
    v_sin_f32 v151, -v151
    v_cvt_pk_bf16_f32 v88, v152, v153
    v_cvt_pk_bf16_f32 v89, v154, v155
    v_cvt_pk_bf16_f32 v90, v156, v157
    v_cvt_pk_bf16_f32 v91, v158, v159
    v_cvt_pk_bf16_f32 v92, v144, v145
    v_cvt_pk_bf16_f32 v93, v146, v147
    v_cvt_pk_bf16_f32 v94, v148, v149
    v_cvt_pk_bf16_f32 v95, v150, v151
    v_mul_f32 v144, v247, v245
    v_add_f32 v247, 0x42000000, v247
    v_fract_f32 v144, v144
    v_add_f32 v145, v144, v245
    v_add_f32 v146, v145, v245
    v_add_f32 v147, v146, v245
    v_add_f32 v148, v147, v245
    v_add_f32 v149, v148, v245
    v_add_f32 v150, v149, v245
    v_add_f32 v151, v150, v245
    v_cos_f32 v152, v144
    v_cos_f32 v153, v145
    v_cos_f32 v154, v146
    v_cos_f32 v155, v147
    v_cos_f32 v156, v148
    v_cos_f32 v157, v149
    v_cos_f32 v158, v150
    v_cos_f32 v159, v151
    v_sin_f32 v144, -v144
    v_sin_f32 v145, -v145
    v_sin_f32 v146, -v146
    v_sin_f32 v147, -v147
    v_sin_f32 v148, -v148
    v_sin_f32 v149, -v149
    v_sin_f32 v150, -v150
    v_sin_f32 v151, -v151
    v_cvt_pk_bf16_f32 v96, v152, v153
    v_cvt_pk_bf16_f32 v97, v154, v155
    v_cvt_pk_bf16_f32 v98, v156, v157
    v_cvt_pk_bf16_f32 v99, v158, v159
    v_cvt_pk_bf16_f32 v100, v144, v145
    v_cvt_pk_bf16_f32 v101, v146, v147
    v_cvt_pk_bf16_f32 v102, v148, v149
    v_cvt_pk_bf16_f32 v103, v150, v151
    v_mul_f32 v144, v247, v245
    v_add_f32 v247, 0x42000000, v247
    v_fract_f32 v144, v144
    v_add_f32 v145, v144, v245
    v_add_f32 v146, v145, v245
    v_add_f32 v147, v146, v245
    v_add_f32 v148, v147, v245
    v_add_f32 v149, v148, v245
    v_add_f32 v150, v149, v245
    v_add_f32 v151, v150, v245
    v_cos_f32 v152, v144
    v_cos_f32 v153, v145
    v_cos_f32 v154, v146
    v_cos_f32 v155, v147
    v_cos_f32 v156, v148
    v_cos_f32 v157, v149
    v_cos_f32 v158, v150
    v_cos_f32 v159, v151
    v_sin_f32 v144, -v144
    v_sin_f32 v145, -v145
    v_sin_f32 v146, -v146
    v_sin_f32 v147, -v147
    v_sin_f32 v148, -v148
    v_sin_f32 v149, -v149
    v_sin_f32 v150, -v150
    v_sin_f32 v151, -v151
    v_cvt_pk_bf16_f32 v104, v152, v153
    v_cvt_pk_bf16_f32 v105, v154, v155
    v_cvt_pk_bf16_f32 v106, v156, v157
    v_cvt_pk_bf16_f32 v107, v158, v159
    v_cvt_pk_bf16_f32 v108, v144, v145
    v_cvt_pk_bf16_f32 v109, v146, v147
    v_cvt_pk_bf16_f32 v110, v148, v149
    v_cvt_pk_bf16_f32 v111, v150, v151
    v_mul_f32 v144, v247, v245
    v_add_f32 v247, 0x42000000, v247
    v_fract_f32 v144, v144
    v_add_f32 v145, v144, v245
    v_add_f32 v146, v145, v245
    v_add_f32 v147, v146, v245
    v_add_f32 v148, v147, v245
    v_add_f32 v149, v148, v245
    v_add_f32 v150, v149, v245
    v_add_f32 v151, v150, v245
    v_cos_f32 v152, v144
    v_cos_f32 v153, v145
    v_cos_f32 v154, v146
    v_cos_f32 v155, v147
    v_cos_f32 v156, v148
    v_cos_f32 v157, v149
    v_cos_f32 v158, v150
    v_cos_f32 v159, v151
    v_sin_f32 v144, -v144
    v_sin_f32 v145, -v145
    v_sin_f32 v146, -v146
    v_sin_f32 v147, -v147
    v_sin_f32 v148, -v148
    v_sin_f32 v149, -v149
    v_sin_f32 v150, -v150
    v_sin_f32 v151, -v151
    v_cvt_pk_bf16_f32 v112, v152, v153
    v_cvt_pk_bf16_f32 v113, v154, v155
    v_cvt_pk_bf16_f32 v114, v156, v157
    v_cvt_pk_bf16_f32 v115, v158, v159
    v_cvt_pk_bf16_f32 v116, v144, v145
    v_cvt_pk_bf16_f32 v117, v146, v147
    v_cvt_pk_bf16_f32 v118, v148, v149
    v_cvt_pk_bf16_f32 v119, v150, v151
    v_mul_f32 v144, v247, v245
    v_add_f32 v247, 0x42000000, v247
    v_fract_f32 v144, v144
    v_add_f32 v145, v144, v245
    v_add_f32 v146, v145, v245
    v_add_f32 v147, v146, v245
    v_add_f32 v148, v147, v245
    v_add_f32 v149, v148, v245
    v_add_f32 v150, v149, v245
    v_add_f32 v151, v150, v245
    v_cos_f32 v152, v144
    v_cos_f32 v153, v145
    v_cos_f32 v154, v146
    v_cos_f32 v155, v147
    v_cos_f32 v156, v148
    v_cos_f32 v157, v149
    v_cos_f32 v158, v150
    v_cos_f32 v159, v151
    v_sin_f32 v144, -v144
    v_sin_f32 v145, -v145
    v_sin_f32 v146, -v146
    v_sin_f32 v147, -v147
    v_sin_f32 v148, -v148
    v_sin_f32 v149, -v149
    v_sin_f32 v150, -v150
    v_sin_f32 v151, -v151
    v_cvt_pk_bf16_f32 v120, v152, v153
    v_cvt_pk_bf16_f32 v121, v154, v155
    v_cvt_pk_bf16_f32 v122, v156, v157
    v_cvt_pk_bf16_f32 v123, v158, v159
    v_cvt_pk_bf16_f32 v124, v144, v145
    v_cvt_pk_bf16_f32 v125, v146, v147
    v_cvt_pk_bf16_f32 v126, v148, v149
    v_cvt_pk_bf16_f32 v127, v150, v151
    v_mul_f32 v144, v247, v245
    v_add_f32 v247, 0x42000000, v247
    v_fract_f32 v144, v144
    v_add_f32 v145, v144, v245
    v_add_f32 v146, v145, v245
    v_add_f32 v147, v146, v245
    v_add_f32 v148, v147, v245
    v_add_f32 v149, v148, v245
    v_add_f32 v150, v149, v245
    v_add_f32 v151, v150, v245
    v_cos_f32 v152, v144
    v_cos_f32 v153, v145
    v_cos_f32 v154, v146
    v_cos_f32 v155, v147
    v_cos_f32 v156, v148
    v_cos_f32 v157, v149
    v_cos_f32 v158, v150
    v_cos_f32 v159, v151
    v_sin_f32 v144, -v144
    v_sin_f32 v145, -v145
    v_sin_f32 v146, -v146
    v_sin_f32 v147, -v147
    v_sin_f32 v148, -v148
    v_sin_f32 v149, -v149
    v_sin_f32 v150, -v150
    v_sin_f32 v151, -v151
    v_cvt_pk_bf16_f32 v128, v152, v153
    v_cvt_pk_bf16_f32 v129, v154, v155
    v_cvt_pk_bf16_f32 v130, v156, v157
    v_cvt_pk_bf16_f32 v131, v158, v159
    v_cvt_pk_bf16_f32 v132, v144, v145
    v_cvt_pk_bf16_f32 v133, v146, v147
    v_cvt_pk_bf16_f32 v134, v148, v149
    v_cvt_pk_bf16_f32 v135, v150, v151
    v_mul_f32 v144, v247, v245
    v_add_f32 v247, 0x42000000, v247
    v_fract_f32 v144, v144
    v_add_f32 v145, v144, v245
    v_add_f32 v146, v145, v245
    v_add_f32 v147, v146, v245
    v_add_f32 v148, v147, v245
    v_add_f32 v149, v148, v245
    v_add_f32 v150, v149, v245
    v_add_f32 v151, v150, v245
    v_cos_f32 v152, v144
    v_cos_f32 v153, v145
    v_cos_f32 v154, v146
    v_cos_f32 v155, v147
    v_cos_f32 v156, v148
    v_cos_f32 v157, v149
    v_cos_f32 v158, v150
    v_cos_f32 v159, v151
    v_sin_f32 v144, -v144
    v_sin_f32 v145, -v145
    v_sin_f32 v146, -v146
    v_sin_f32 v147, -v147
    v_sin_f32 v148, -v148
    v_sin_f32 v149, -v149
    v_sin_f32 v150, -v150
    v_sin_f32 v151, -v151
    v_cvt_pk_bf16_f32 v136, v152, v153
    v_cvt_pk_bf16_f32 v137, v154, v155
    v_cvt_pk_bf16_f32 v138, v156, v157
    v_cvt_pk_bf16_f32 v139, v158, v159
    v_cvt_pk_bf16_f32 v140, v144, v145
    v_cvt_pk_bf16_f32 v141, v146, v147
    v_cvt_pk_bf16_f32 v142, v148, v149
    v_cvt_pk_bf16_f32 v143, v150, v151
    s_cmp_lg_u32 s41, 0
    s_cbranch_scc1 L_Ac1
    s_mov_b32 exec_lo, 0x10001
    s_mov_b32 exec_hi, 0x10001
    s_mov_b32 s6, 0xbf803f80
    v_mov_b32 v76, s6
    v_mov_b32 v77, s6
    v_mov_b32 v78, s6
    v_mov_b32 v79, s6
    v_mov_b32 v84, s6
    v_mov_b32 v85, s6
    v_mov_b32 v86, s6
    v_mov_b32 v87, s6
    v_mov_b32 v92, s6
    v_mov_b32 v93, s6
    v_mov_b32 v94, s6
    v_mov_b32 v95, s6
    v_mov_b32 v100, s6
    v_mov_b32 v101, s6
    v_mov_b32 v102, s6
    v_mov_b32 v103, s6
    v_mov_b32 v108, s6
    v_mov_b32 v109, s6
    v_mov_b32 v110, s6
    v_mov_b32 v111, s6
    v_mov_b32 v116, s6
    v_mov_b32 v117, s6
    v_mov_b32 v118, s6
    v_mov_b32 v119, s6
    v_mov_b32 v124, s6
    v_mov_b32 v125, s6
    v_mov_b32 v126, s6
    v_mov_b32 v127, s6
    v_mov_b32 v132, s6
    v_mov_b32 v133, s6
    v_mov_b32 v134, s6
    v_mov_b32 v135, s6
    v_mov_b32 v140, s6
    v_mov_b32 v141, s6
    v_mov_b32 v142, s6
    v_mov_b32 v143, s6
    s_mov_b64 exec, -1
L_Ac1:
    v_lshrrev_b32 v1, 1, v240
    v_cvt_f32_u32 v1, v1
    v_mul_f32 v1, 0x3c800000, v1
    v_and_b32 v2, 1, v240
    v_cvt_f32_u32 v2, v2
    v_mul_f32 v2, 0x3e800000, v2
    v_lshlrev_b32 v3, 3, v241
    v_cvt_f32_u32 v3, v3
    v_add_f32 v4, 0x42000000, v3
    v_cmp_eq_u32 vcc, 1, v240
    s_nop 1
    v_cndmask_b32 v5, v1, 0.5, vcc
    v_cndmask_b32 v6, v2, 0, vcc
    v_fma_f32 v144, v3, v5, v6
    v_add_f32 v145, v144, v5
    v_add_f32 v146, v145, v5
    v_add_f32 v147, v146, v5
    v_add_f32 v148, v147, v5
    v_add_f32 v149, v148, v5
    v_add_f32 v150, v149, v5
    v_add_f32 v151, v150, v5
    v_cos_f32 v144, v144
    v_cos_f32 v145, v145
    v_cos_f32 v146, v146
    v_cos_f32 v147, v147
    v_cos_f32 v148, v148
    v_cos_f32 v149, v149
    v_cos_f32 v150, v150
    v_cos_f32 v151, v151
    v_cvt_pk_bf16_f32 v208, v144, v145
    v_cvt_pk_bf16_f32 v209, v146, v147
    v_cvt_pk_bf16_f32 v210, v148, v149
    v_cvt_pk_bf16_f32 v211, v150, v151
    v_fma_f32 v144, v4, v5, v6
    v_add_f32 v145, v144, v5
    v_add_f32 v146, v145, v5
    v_add_f32 v147, v146, v5
    v_add_f32 v148, v147, v5
    v_add_f32 v149, v148, v5
    v_add_f32 v150, v149, v5
    v_add_f32 v151, v150, v5
    v_cos_f32 v144, v144
    v_cos_f32 v145, v145
    v_cos_f32 v146, v146
    v_cos_f32 v147, v147
    v_cos_f32 v148, v148
    v_cos_f32 v149, v149
    v_cos_f32 v150, v150
    v_cos_f32 v151, v151
    v_cvt_pk_bf16_f32 v212, v144, v145
    v_cvt_pk_bf16_f32 v213, v146, v147
    v_cvt_pk_bf16_f32 v214, v148, v149
    v_cvt_pk_bf16_f32 v215, v150, v151
    v_add_f32 v1, 0x3e000000, v1
    v_fma_f32 v144, v3, v1, v2
    v_add_f32 v145, v144, v1
    v_add_f32 v146, v145, v1
    v_add_f32 v147, v146, v1
    v_add_f32 v148, v147, v1
    v_add_f32 v149, v148, v1
    v_add_f32 v150, v149, v1
    v_add_f32 v151, v150, v1
    v_cos_f32 v144, v144
    v_cos_f32 v145, v145
    v_cos_f32 v146, v146
    v_cos_f32 v147, v147
    v_cos_f32 v148, v148
    v_cos_f32 v149, v149
    v_cos_f32 v150, v150
    v_cos_f32 v151, v151
    v_cvt_pk_bf16_f32 v216, v144, v145
    v_cvt_pk_bf16_f32 v217, v146, v147
    v_cvt_pk_bf16_f32 v218, v148, v149
    v_cvt_pk_bf16_f32 v219, v150, v151
    v_fma_f32 v144, v4, v1, v2
    v_add_f32 v145, v144, v1
    v_add_f32 v146, v145, v1
    v_add_f32 v147, v146, v1
    v_add_f32 v148, v147, v1
    v_add_f32 v149, v148, v1
    v_add_f32 v150, v149, v1
    v_add_f32 v151, v150, v1
    v_cos_f32 v144, v144
    v_cos_f32 v145, v145
    v_cos_f32 v146, v146
    v_cos_f32 v147, v147
    v_cos_f32 v148, v148
    v_cos_f32 v149, v149
    v_cos_f32 v150, v150
    v_cos_f32 v151, v151
    v_cvt_pk_bf16_f32 v220, v144, v145
    v_cvt_pk_bf16_f32 v221, v146, v147
    v_cvt_pk_bf16_f32 v222, v148, v149
    v_cvt_pk_bf16_f32 v223, v150, v151
    v_add_f32 v1, 0x3e000000, v1
    v_fma_f32 v144, v3, v1, v2
    v_add_f32 v145, v144, v1
    v_add_f32 v146, v145, v1
    v_add_f32 v147, v146, v1
    v_add_f32 v148, v147, v1
    v_add_f32 v149, v148, v1
    v_add_f32 v150, v149, v1
    v_add_f32 v151, v150, v1
    v_cos_f32 v144, v144
    v_cos_f32 v145, v145
    v_cos_f32 v146, v146
    v_cos_f32 v147, v147
    v_cos_f32 v148, v148
    v_cos_f32 v149, v149
    v_cos_f32 v150, v150
    v_cos_f32 v151, v151
    v_cvt_pk_bf16_f32 v224, v144, v145
    v_cvt_pk_bf16_f32 v225, v146, v147
    v_cvt_pk_bf16_f32 v226, v148, v149
    v_cvt_pk_bf16_f32 v227, v150, v151
    v_fma_f32 v144, v4, v1, v2
    v_add_f32 v145, v144, v1
    v_add_f32 v146, v145, v1
    v_add_f32 v147, v146, v1
    v_add_f32 v148, v147, v1
    v_add_f32 v149, v148, v1
    v_add_f32 v150, v149, v1
    v_add_f32 v151, v150, v1
    v_cos_f32 v144, v144
    v_cos_f32 v145, v145
    v_cos_f32 v146, v146
    v_cos_f32 v147, v147
    v_cos_f32 v148, v148
    v_cos_f32 v149, v149
    v_cos_f32 v150, v150
    v_cos_f32 v151, v151
    v_cvt_pk_bf16_f32 v228, v144, v145
    v_cvt_pk_bf16_f32 v229, v146, v147
    v_cvt_pk_bf16_f32 v230, v148, v149
    v_cvt_pk_bf16_f32 v231, v150, v151
    v_add_f32 v1, 0x3e000000, v1
    v_fma_f32 v144, v3, v1, v2
    v_add_f32 v145, v144, v1
    v_add_f32 v146, v145, v1
    v_add_f32 v147, v146, v1
    v_add_f32 v148, v147, v1
    v_add_f32 v149, v148, v1
    v_add_f32 v150, v149, v1
    v_add_f32 v151, v150, v1
    v_cos_f32 v144, v144
    v_cos_f32 v145, v145
    v_cos_f32 v146, v146
    v_cos_f32 v147, v147
    v_cos_f32 v148, v148
    v_cos_f32 v149, v149
    v_cos_f32 v150, v150
    v_cos_f32 v151, v151
    v_cvt_pk_bf16_f32 v232, v144, v145
    v_cvt_pk_bf16_f32 v233, v146, v147
    v_cvt_pk_bf16_f32 v234, v148, v149
    v_cvt_pk_bf16_f32 v235, v150, v151
    v_fma_f32 v144, v4, v1, v2
    v_add_f32 v145, v144, v1
    v_add_f32 v146, v145, v1
    v_add_f32 v147, v146, v1
    v_add_f32 v148, v147, v1
    v_add_f32 v149, v148, v1
    v_add_f32 v150, v149, v1
    v_add_f32 v151, v150, v1
    v_cos_f32 v144, v144
    v_cos_f32 v145, v145
    v_cos_f32 v146, v146
    v_cos_f32 v147, v147
    v_cos_f32 v148, v148
    v_cos_f32 v149, v149
    v_cos_f32 v150, v150
    v_cos_f32 v151, v151
    v_cvt_pk_bf16_f32 v236, v144, v145
    v_cvt_pk_bf16_f32 v237, v146, v147
    v_cvt_pk_bf16_f32 v238, v148, v149
    v_cvt_pk_bf16_f32 v239, v150, v151
    v_bfe_u32 v6, v0, 1, 2
    v_and_b32 v7, 1, v0
    v_bfe_u32 v4, v0, 3, 1
    v_lshl_add_u32 v7, v4, 1, v7
    v_and_b32 v4, 0x30, v0
    v_lshl_add_u32 v7, v7, 7, v4
    v_mul_u32_u24 v2, 1056, v6
    v_add_u32 v2, v2, v7
    v_add_u32 v3, 50688, v2
    v_add_u32 v4, 101376, v2
    s_waitcnt lgkmcnt(0)
    s_barrier
    ds_read_b128 v[144:147], v2 offset:0
    ds_read_b128 v[148:151], v2 offset:512
    ds_read_b128 v[152:155], v2 offset:4224
    ds_read_b128 v[156:159], v2 offset:4736
    ds_read_b128 v[160:163], v2 offset:8448
    ds_read_b128 v[164:167], v2 offset:8960
    ds_read_b128 v[168:171], v2 offset:12672
    ds_read_b128 v[172:175], v2 offset:13184
    s_waitcnt lgkmcnt(4)
    v_mfma_f32_16x16x32_bf16 v[8:11], v[144:147], v[72:75], 0
    ds_read_b128 v[176:179], v2 offset:64
    v_mfma_f32_16x16x32_bf16 v[40:43], v[144:147], v[76:79], 0
    ds_read_b128 v[180:183], v2 offset:576
    v_mfma_f32_16x16x32_bf16 v[12:15], v[148:151], v[72:75], 0
    ds_read_b128 v[184:187], v2 offset:4288
    v_mfma_f32_16x16x32_bf16 v[44:47], v[148:151], v[76:79], 0
    ds_read_b128 v[188:191], v2 offset:4800
    v_mfma_f32_16x16x32_bf16 v[16:19], v[152:155], v[72:75], 0
    ds_read_b128 v[192:195], v2 offset:8512
    v_mfma_f32_16x16x32_bf16 v[48:51], v[152:155], v[76:79], 0
    ds_read_b128 v[196:199], v2 offset:9024
    v_mfma_f32_16x16x32_bf16 v[20:23], v[156:159], v[72:75], 0
    ds_read_b128 v[200:203], v2 offset:12736
    v_mfma_f32_16x16x32_bf16 v[52:55], v[156:159], v[76:79], 0
    ds_read_b128 v[204:207], v2 offset:13248
    s_waitcnt lgkmcnt(4)
    v_mfma_f32_16x16x32_bf16 v[24:27], v[160:163], v[72:75], 0
    v_mfma_f32_16x16x32_bf16 v[56:59], v[160:163], v[76:79], 0
    v_mfma_f32_16x16x32_bf16 v[28:31], v[164:167], v[72:75], 0
    v_mfma_f32_16x16x32_bf16 v[60:63], v[164:167], v[76:79], 0
    v_mfma_f32_16x16x32_bf16 v[32:35], v[168:171], v[72:75], 0
    v_mfma_f32_16x16x32_bf16 v[64:67], v[168:171], v[76:79], 0
    v_mfma_f32_16x16x32_bf16 v[36:39], v[172:175], v[72:75], 0
    v_mfma_f32_16x16x32_bf16 v[68:71], v[172:175], v[76:79], 0
    s_barrier
    v_mfma_f32_16x16x32_bf16 v[8:11], v[176:179], v[80:83], v[8:11]
    ds_read_b128 v[144:147], v2 offset:16896
    v_mfma_f32_16x16x32_bf16 v[40:43], v[176:179], v[84:87], v[40:43]
    ds_read_b128 v[148:151], v2 offset:17408
    v_mfma_f32_16x16x32_bf16 v[12:15], v[180:183], v[80:83], v[12:15]
    ds_read_b128 v[152:155], v2 offset:21120
    v_mfma_f32_16x16x32_bf16 v[44:47], v[180:183], v[84:87], v[44:47]
    ds_read_b128 v[156:159], v2 offset:21632
    v_mfma_f32_16x16x32_bf16 v[16:19], v[184:187], v[80:83], v[16:19]
    ds_read_b128 v[160:163], v2 offset:25344
    v_mfma_f32_16x16x32_bf16 v[48:51], v[184:187], v[84:87], v[48:51]
    ds_read_b128 v[164:167], v2 offset:25856
    v_mfma_f32_16x16x32_bf16 v[20:23], v[188:191], v[80:83], v[20:23]
    ds_read_b128 v[168:171], v2 offset:29568
    v_mfma_f32_16x16x32_bf16 v[52:55], v[188:191], v[84:87], v[52:55]
    ds_read_b128 v[172:175], v2 offset:30080
    s_waitcnt lgkmcnt(4)
    v_mfma_f32_16x16x32_bf16 v[24:27], v[192:195], v[80:83], v[24:27]
    v_xor_b32 v72, v246, v72
    v_mfma_f32_16x16x32_bf16 v[56:59], v[192:195], v[84:87], v[56:59]
    v_xor_b32 v73, v246, v73
    v_mfma_f32_16x16x32_bf16 v[28:31], v[196:199], v[80:83], v[28:31]
    v_xor_b32 v74, v246, v74
    v_mfma_f32_16x16x32_bf16 v[60:63], v[196:199], v[84:87], v[60:63]
    v_xor_b32 v75, v246, v75
    v_mfma_f32_16x16x32_bf16 v[32:35], v[200:203], v[80:83], v[32:35]
    v_xor_b32 v76, v246, v76
    v_mfma_f32_16x16x32_bf16 v[64:67], v[200:203], v[84:87], v[64:67]
    v_xor_b32 v77, v246, v77
    v_mfma_f32_16x16x32_bf16 v[36:39], v[204:207], v[80:83], v[36:39]
    v_xor_b32 v78, v246, v78
    v_mfma_f32_16x16x32_bf16 v[68:71], v[204:207], v[84:87], v[68:71]
    v_xor_b32 v79, v246, v79
    v_mfma_f32_16x16x32_bf16 v[8:11], v[144:147], v[88:91], v[8:11]
    ds_read_b128 v[176:179], v2 offset:16960
    v_mfma_f32_16x16x32_bf16 v[40:43], v[144:147], v[92:95], v[40:43]
    ds_read_b128 v[180:183], v2 offset:17472
    v_mfma_f32_16x16x32_bf16 v[12:15], v[148:151], v[88:91], v[12:15]
    ds_read_b128 v[184:187], v2 offset:21184
    v_mfma_f32_16x16x32_bf16 v[44:47], v[148:151], v[92:95], v[44:47]
    ds_read_b128 v[188:191], v2 offset:21696
    v_mfma_f32_16x16x32_bf16 v[16:19], v[152:155], v[88:91], v[16:19]
    ds_read_b128 v[192:195], v2 offset:25408
    v_mfma_f32_16x16x32_bf16 v[48:51], v[152:155], v[92:95], v[48:51]
    ds_read_b128 v[196:199], v2 offset:25920
    v_mfma_f32_16x16x32_bf16 v[20:23], v[156:159], v[88:91], v[20:23]
    ds_read_b128 v[200:203], v2 offset:29632
    v_mfma_f32_16x16x32_bf16 v[52:55], v[156:159], v[92:95], v[52:55]
    ds_read_b128 v[204:207], v2 offset:30144
    s_waitcnt lgkmcnt(4)
    v_mfma_f32_16x16x32_bf16 v[24:27], v[160:163], v[88:91], v[24:27]
    v_xor_b32 v80, v246, v80
    v_mfma_f32_16x16x32_bf16 v[56:59], v[160:163], v[92:95], v[56:59]
    v_xor_b32 v81, v246, v81
    v_mfma_f32_16x16x32_bf16 v[28:31], v[164:167], v[88:91], v[28:31]
    v_xor_b32 v82, v246, v82
    v_mfma_f32_16x16x32_bf16 v[60:63], v[164:167], v[92:95], v[60:63]
    v_xor_b32 v83, v246, v83
    v_mfma_f32_16x16x32_bf16 v[32:35], v[168:171], v[88:91], v[32:35]
    v_xor_b32 v84, v246, v84
    v_mfma_f32_16x16x32_bf16 v[64:67], v[168:171], v[92:95], v[64:67]
    v_xor_b32 v85, v246, v85
    v_mfma_f32_16x16x32_bf16 v[36:39], v[172:175], v[88:91], v[36:39]
    v_xor_b32 v86, v246, v86
    v_mfma_f32_16x16x32_bf16 v[68:71], v[172:175], v[92:95], v[68:71]
    v_xor_b32 v87, v246, v87
    s_barrier
    v_mfma_f32_16x16x32_bf16 v[8:11], v[176:179], v[96:99], v[8:11]
    ds_read_b128 v[144:147], v2 offset:33792
    v_mfma_f32_16x16x32_bf16 v[40:43], v[176:179], v[100:103], v[40:43]
    ds_read_b128 v[148:151], v2 offset:34304
    v_mfma_f32_16x16x32_bf16 v[12:15], v[180:183], v[96:99], v[12:15]
    ds_read_b128 v[152:155], v2 offset:38016
    v_mfma_f32_16x16x32_bf16 v[44:47], v[180:183], v[100:103], v[44:47]
    ds_read_b128 v[156:159], v2 offset:38528
    v_mfma_f32_16x16x32_bf16 v[16:19], v[184:187], v[96:99], v[16:19]
    ds_read_b128 v[160:163], v2 offset:42240
    v_mfma_f32_16x16x32_bf16 v[48:51], v[184:187], v[100:103], v[48:51]
    ds_read_b128 v[164:167], v2 offset:42752
    v_mfma_f32_16x16x32_bf16 v[20:23], v[188:191], v[96:99], v[20:23]
    ds_read_b128 v[168:171], v2 offset:46464
    v_mfma_f32_16x16x32_bf16 v[52:55], v[188:191], v[100:103], v[52:55]
    ds_read_b128 v[172:175], v2 offset:46976
    s_waitcnt lgkmcnt(4)
    v_mfma_f32_16x16x32_bf16 v[24:27], v[192:195], v[96:99], v[24:27]
    v_xor_b32 v88, v246, v88
    v_mfma_f32_16x16x32_bf16 v[56:59], v[192:195], v[100:103], v[56:59]
    v_xor_b32 v89, v246, v89
    v_mfma_f32_16x16x32_bf16 v[28:31], v[196:199], v[96:99], v[28:31]
    v_xor_b32 v90, v246, v90
    v_mfma_f32_16x16x32_bf16 v[60:63], v[196:199], v[100:103], v[60:63]
    v_xor_b32 v91, v246, v91
    v_mfma_f32_16x16x32_bf16 v[32:35], v[200:203], v[96:99], v[32:35]
    v_xor_b32 v92, v246, v92
    v_mfma_f32_16x16x32_bf16 v[64:67], v[200:203], v[100:103], v[64:67]
    v_xor_b32 v93, v246, v93
    v_mfma_f32_16x16x32_bf16 v[36:39], v[204:207], v[96:99], v[36:39]
    v_xor_b32 v94, v246, v94
    v_mfma_f32_16x16x32_bf16 v[68:71], v[204:207], v[100:103], v[68:71]
    v_xor_b32 v95, v246, v95
    v_mfma_f32_16x16x32_bf16 v[8:11], v[144:147], v[104:107], v[8:11]
    ds_read_b128 v[176:179], v2 offset:33856
    v_mfma_f32_16x16x32_bf16 v[40:43], v[144:147], v[108:111], v[40:43]
    ds_read_b128 v[180:183], v2 offset:34368
    v_mfma_f32_16x16x32_bf16 v[12:15], v[148:151], v[104:107], v[12:15]
    ds_read_b128 v[184:187], v2 offset:38080
    v_mfma_f32_16x16x32_bf16 v[44:47], v[148:151], v[108:111], v[44:47]
    ds_read_b128 v[188:191], v2 offset:38592
    v_mfma_f32_16x16x32_bf16 v[16:19], v[152:155], v[104:107], v[16:19]
    ds_read_b128 v[192:195], v2 offset:42304
    v_mfma_f32_16x16x32_bf16 v[48:51], v[152:155], v[108:111], v[48:51]
    ds_read_b128 v[196:199], v2 offset:42816
    v_mfma_f32_16x16x32_bf16 v[20:23], v[156:159], v[104:107], v[20:23]
    ds_read_b128 v[200:203], v2 offset:46528
    v_mfma_f32_16x16x32_bf16 v[52:55], v[156:159], v[108:111], v[52:55]
    ds_read_b128 v[204:207], v2 offset:47040
    s_waitcnt lgkmcnt(4)
    v_mfma_f32_16x16x32_bf16 v[24:27], v[160:163], v[104:107], v[24:27]
    v_xor_b32 v96, v246, v96
    v_mfma_f32_16x16x32_bf16 v[56:59], v[160:163], v[108:111], v[56:59]
    v_xor_b32 v97, v246, v97
    v_mfma_f32_16x16x32_bf16 v[28:31], v[164:167], v[104:107], v[28:31]
    v_xor_b32 v98, v246, v98
    v_mfma_f32_16x16x32_bf16 v[60:63], v[164:167], v[108:111], v[60:63]
    v_xor_b32 v99, v246, v99
    v_mfma_f32_16x16x32_bf16 v[32:35], v[168:171], v[104:107], v[32:35]
    v_xor_b32 v100, v246, v100
    v_mfma_f32_16x16x32_bf16 v[64:67], v[168:171], v[108:111], v[64:67]
    v_xor_b32 v101, v246, v101
    v_mfma_f32_16x16x32_bf16 v[36:39], v[172:175], v[104:107], v[36:39]
    v_xor_b32 v102, v246, v102
    v_mfma_f32_16x16x32_bf16 v[68:71], v[172:175], v[108:111], v[68:71]
    v_xor_b32 v103, v246, v103
    s_barrier
    v_mfma_f32_16x16x32_bf16 v[8:11], v[176:179], v[112:115], v[8:11]
    ds_read_b128 v[144:147], v3 offset:0
    v_mfma_f32_16x16x32_bf16 v[40:43], v[176:179], v[116:119], v[40:43]
    ds_read_b128 v[148:151], v3 offset:512
    v_mfma_f32_16x16x32_bf16 v[12:15], v[180:183], v[112:115], v[12:15]
    ds_read_b128 v[152:155], v3 offset:4224
    v_mfma_f32_16x16x32_bf16 v[44:47], v[180:183], v[116:119], v[44:47]
    ds_read_b128 v[156:159], v3 offset:4736
    v_mfma_f32_16x16x32_bf16 v[16:19], v[184:187], v[112:115], v[16:19]
    ds_read_b128 v[160:163], v3 offset:8448
    v_mfma_f32_16x16x32_bf16 v[48:51], v[184:187], v[116:119], v[48:51]
    ds_read_b128 v[164:167], v3 offset:8960
    v_mfma_f32_16x16x32_bf16 v[20:23], v[188:191], v[112:115], v[20:23]
    ds_read_b128 v[168:171], v3 offset:12672
    v_mfma_f32_16x16x32_bf16 v[52:55], v[188:191], v[116:119], v[52:55]
    ds_read_b128 v[172:175], v3 offset:13184
    s_waitcnt lgkmcnt(4)
    v_mfma_f32_16x16x32_bf16 v[24:27], v[192:195], v[112:115], v[24:27]
    v_xor_b32 v104, v246, v104
    v_mfma_f32_16x16x32_bf16 v[56:59], v[192:195], v[116:119], v[56:59]
    v_xor_b32 v105, v246, v105
    v_mfma_f32_16x16x32_bf16 v[28:31], v[196:199], v[112:115], v[28:31]
    v_xor_b32 v106, v246, v106
    v_mfma_f32_16x16x32_bf16 v[60:63], v[196:199], v[116:119], v[60:63]
    v_xor_b32 v107, v246, v107
    v_mfma_f32_16x16x32_bf16 v[32:35], v[200:203], v[112:115], v[32:35]
    v_xor_b32 v108, v246, v108
    v_mfma_f32_16x16x32_bf16 v[64:67], v[200:203], v[116:119], v[64:67]
    v_xor_b32 v109, v246, v109
    v_mfma_f32_16x16x32_bf16 v[36:39], v[204:207], v[112:115], v[36:39]
    v_xor_b32 v110, v246, v110
    v_mfma_f32_16x16x32_bf16 v[68:71], v[204:207], v[116:119], v[68:71]
    v_xor_b32 v111, v246, v111
    v_mfma_f32_16x16x32_bf16 v[8:11], v[144:147], v[120:123], v[8:11]
    ds_read_b128 v[176:179], v3 offset:64
    v_mfma_f32_16x16x32_bf16 v[40:43], v[144:147], v[124:127], v[40:43]
    ds_read_b128 v[180:183], v3 offset:576
    v_mfma_f32_16x16x32_bf16 v[12:15], v[148:151], v[120:123], v[12:15]
    ds_read_b128 v[184:187], v3 offset:4288
    v_mfma_f32_16x16x32_bf16 v[44:47], v[148:151], v[124:127], v[44:47]
    ds_read_b128 v[188:191], v3 offset:4800
    v_mfma_f32_16x16x32_bf16 v[16:19], v[152:155], v[120:123], v[16:19]
    ds_read_b128 v[192:195], v3 offset:8512
    v_mfma_f32_16x16x32_bf16 v[48:51], v[152:155], v[124:127], v[48:51]
    ds_read_b128 v[196:199], v3 offset:9024
    v_mfma_f32_16x16x32_bf16 v[20:23], v[156:159], v[120:123], v[20:23]
    ds_read_b128 v[200:203], v3 offset:12736
    v_mfma_f32_16x16x32_bf16 v[52:55], v[156:159], v[124:127], v[52:55]
    ds_read_b128 v[204:207], v3 offset:13248
    s_waitcnt lgkmcnt(4)
    v_mfma_f32_16x16x32_bf16 v[24:27], v[160:163], v[120:123], v[24:27]
    v_xor_b32 v112, v246, v112
    v_mfma_f32_16x16x32_bf16 v[56:59], v[160:163], v[124:127], v[56:59]
    v_xor_b32 v113, v246, v113
    v_mfma_f32_16x16x32_bf16 v[28:31], v[164:167], v[120:123], v[28:31]
    v_xor_b32 v114, v246, v114
    v_mfma_f32_16x16x32_bf16 v[60:63], v[164:167], v[124:127], v[60:63]
    v_xor_b32 v115, v246, v115
    v_mfma_f32_16x16x32_bf16 v[32:35], v[168:171], v[120:123], v[32:35]
    v_xor_b32 v116, v246, v116
    v_mfma_f32_16x16x32_bf16 v[64:67], v[168:171], v[124:127], v[64:67]
    v_xor_b32 v117, v246, v117
    v_mfma_f32_16x16x32_bf16 v[36:39], v[172:175], v[120:123], v[36:39]
    v_xor_b32 v118, v246, v118
    v_mfma_f32_16x16x32_bf16 v[68:71], v[172:175], v[124:127], v[68:71]
    v_xor_b32 v119, v246, v119
    s_barrier
    v_mfma_f32_16x16x32_bf16 v[8:11], v[176:179], v[128:131], v[8:11]
    ds_read_b128 v[144:147], v3 offset:16896
    v_mfma_f32_16x16x32_bf16 v[40:43], v[176:179], v[132:135], v[40:43]
    ds_read_b128 v[148:151], v3 offset:17408
    v_mfma_f32_16x16x32_bf16 v[12:15], v[180:183], v[128:131], v[12:15]
    ds_read_b128 v[152:155], v3 offset:21120
    v_mfma_f32_16x16x32_bf16 v[44:47], v[180:183], v[132:135], v[44:47]
    ds_read_b128 v[156:159], v3 offset:21632
    v_mfma_f32_16x16x32_bf16 v[16:19], v[184:187], v[128:131], v[16:19]
    ds_read_b128 v[160:163], v3 offset:25344
    v_mfma_f32_16x16x32_bf16 v[48:51], v[184:187], v[132:135], v[48:51]
    ds_read_b128 v[164:167], v3 offset:25856
    v_mfma_f32_16x16x32_bf16 v[20:23], v[188:191], v[128:131], v[20:23]
    ds_read_b128 v[168:171], v3 offset:29568
    v_mfma_f32_16x16x32_bf16 v[52:55], v[188:191], v[132:135], v[52:55]
    ds_read_b128 v[172:175], v3 offset:30080
    s_waitcnt lgkmcnt(4)
    v_mfma_f32_16x16x32_bf16 v[24:27], v[192:195], v[128:131], v[24:27]
    v_xor_b32 v120, v246, v120
    v_mfma_f32_16x16x32_bf16 v[56:59], v[192:195], v[132:135], v[56:59]
    v_xor_b32 v121, v246, v121
    v_mfma_f32_16x16x32_bf16 v[28:31], v[196:199], v[128:131], v[28:31]
    v_xor_b32 v122, v246, v122
    v_mfma_f32_16x16x32_bf16 v[60:63], v[196:199], v[132:135], v[60:63]
    v_xor_b32 v123, v246, v123
    v_mfma_f32_16x16x32_bf16 v[32:35], v[200:203], v[128:131], v[32:35]
    v_xor_b32 v124, v246, v124
    v_mfma_f32_16x16x32_bf16 v[64:67], v[200:203], v[132:135], v[64:67]
    v_xor_b32 v125, v246, v125
    v_mfma_f32_16x16x32_bf16 v[36:39], v[204:207], v[128:131], v[36:39]
    v_xor_b32 v126, v246, v126
    v_mfma_f32_16x16x32_bf16 v[68:71], v[204:207], v[132:135], v[68:71]
    v_xor_b32 v127, v246, v127
    v_mfma_f32_16x16x32_bf16 v[8:11], v[144:147], v[136:139], v[8:11]
    ds_read_b128 v[176:179], v3 offset:16960
    v_mfma_f32_16x16x32_bf16 v[40:43], v[144:147], v[140:143], v[40:43]
    ds_read_b128 v[180:183], v3 offset:17472
    v_mfma_f32_16x16x32_bf16 v[12:15], v[148:151], v[136:139], v[12:15]
    ds_read_b128 v[184:187], v3 offset:21184
    v_mfma_f32_16x16x32_bf16 v[44:47], v[148:151], v[140:143], v[44:47]
    ds_read_b128 v[188:191], v3 offset:21696
    v_mfma_f32_16x16x32_bf16 v[16:19], v[152:155], v[136:139], v[16:19]
    ds_read_b128 v[192:195], v3 offset:25408
    v_mfma_f32_16x16x32_bf16 v[48:51], v[152:155], v[140:143], v[48:51]
    ds_read_b128 v[196:199], v3 offset:25920
    v_mfma_f32_16x16x32_bf16 v[20:23], v[156:159], v[136:139], v[20:23]
    ds_read_b128 v[200:203], v3 offset:29632
    v_mfma_f32_16x16x32_bf16 v[52:55], v[156:159], v[140:143], v[52:55]
    ds_read_b128 v[204:207], v3 offset:30144
    s_waitcnt lgkmcnt(4)
    v_mfma_f32_16x16x32_bf16 v[24:27], v[160:163], v[136:139], v[24:27]
    v_xor_b32 v128, v246, v128
    v_mfma_f32_16x16x32_bf16 v[56:59], v[160:163], v[140:143], v[56:59]
    v_xor_b32 v129, v246, v129
    v_mfma_f32_16x16x32_bf16 v[28:31], v[164:167], v[136:139], v[28:31]
    v_xor_b32 v130, v246, v130
    v_mfma_f32_16x16x32_bf16 v[60:63], v[164:167], v[140:143], v[60:63]
    v_xor_b32 v131, v246, v131
    v_mfma_f32_16x16x32_bf16 v[32:35], v[168:171], v[136:139], v[32:35]
    v_xor_b32 v132, v246, v132
    v_mfma_f32_16x16x32_bf16 v[64:67], v[168:171], v[140:143], v[64:67]
    v_xor_b32 v133, v246, v133
    v_mfma_f32_16x16x32_bf16 v[36:39], v[172:175], v[136:139], v[36:39]
    v_xor_b32 v134, v246, v134
    v_mfma_f32_16x16x32_bf16 v[68:71], v[172:175], v[140:143], v[68:71]
    v_xor_b32 v135, v246, v135
    s_barrier
    v_mfma_f32_16x16x32_bf16 v[8:11], v[176:179], v[72:75], v[8:11]
    ds_read_b128 v[144:147], v3 offset:33792
    v_mfma_f32_16x16x32_bf16 v[40:43], v[176:179], v[76:79], v[40:43]
    ds_read_b128 v[148:151], v3 offset:34304
    v_mfma_f32_16x16x32_bf16 v[12:15], v[180:183], v[72:75], v[12:15]
    ds_read_b128 v[152:155], v3 offset:38016
    v_mfma_f32_16x16x32_bf16 v[44:47], v[180:183], v[76:79], v[44:47]
    ds_read_b128 v[156:159], v3 offset:38528
    v_mfma_f32_16x16x32_bf16 v[16:19], v[184:187], v[72:75], v[16:19]
    ds_read_b128 v[160:163], v3 offset:42240
    v_mfma_f32_16x16x32_bf16 v[48:51], v[184:187], v[76:79], v[48:51]
    ds_read_b128 v[164:167], v3 offset:42752
    v_mfma_f32_16x16x32_bf16 v[20:23], v[188:191], v[72:75], v[20:23]
    ds_read_b128 v[168:171], v3 offset:46464
    v_mfma_f32_16x16x32_bf16 v[52:55], v[188:191], v[76:79], v[52:55]
    ds_read_b128 v[172:175], v3 offset:46976
    s_waitcnt lgkmcnt(4)
    v_mfma_f32_16x16x32_bf16 v[24:27], v[192:195], v[72:75], v[24:27]
    v_xor_b32 v136, v246, v136
    v_mfma_f32_16x16x32_bf16 v[56:59], v[192:195], v[76:79], v[56:59]
    v_xor_b32 v137, v246, v137
    v_mfma_f32_16x16x32_bf16 v[28:31], v[196:199], v[72:75], v[28:31]
    v_xor_b32 v138, v246, v138
    v_mfma_f32_16x16x32_bf16 v[60:63], v[196:199], v[76:79], v[60:63]
    v_xor_b32 v139, v246, v139
    v_mfma_f32_16x16x32_bf16 v[32:35], v[200:203], v[72:75], v[32:35]
    v_xor_b32 v140, v246, v140
    v_mfma_f32_16x16x32_bf16 v[64:67], v[200:203], v[76:79], v[64:67]
    v_xor_b32 v141, v246, v141
    v_mfma_f32_16x16x32_bf16 v[36:39], v[204:207], v[72:75], v[36:39]
    v_xor_b32 v142, v246, v142
    v_mfma_f32_16x16x32_bf16 v[68:71], v[204:207], v[76:79], v[68:71]
    v_xor_b32 v143, v246, v143
    v_mfma_f32_16x16x32_bf16 v[8:11], v[144:147], v[80:83], v[8:11]
    ds_read_b128 v[176:179], v3 offset:33856
    v_mfma_f32_16x16x32_bf16 v[40:43], v[144:147], v[84:87], v[40:43]
    ds_read_b128 v[180:183], v3 offset:34368
    v_mfma_f32_16x16x32_bf16 v[12:15], v[148:151], v[80:83], v[12:15]
    ds_read_b128 v[184:187], v3 offset:38080
    v_mfma_f32_16x16x32_bf16 v[44:47], v[148:151], v[84:87], v[44:47]
    ds_read_b128 v[188:191], v3 offset:38592
    v_mfma_f32_16x16x32_bf16 v[16:19], v[152:155], v[80:83], v[16:19]
    ds_read_b128 v[192:195], v3 offset:42304
    v_mfma_f32_16x16x32_bf16 v[48:51], v[152:155], v[84:87], v[48:51]
    ds_read_b128 v[196:199], v3 offset:42816
    v_mfma_f32_16x16x32_bf16 v[20:23], v[156:159], v[80:83], v[20:23]
    ds_read_b128 v[200:203], v3 offset:46528
    v_mfma_f32_16x16x32_bf16 v[52:55], v[156:159], v[84:87], v[52:55]
    ds_read_b128 v[204:207], v3 offset:47040
    s_waitcnt lgkmcnt(4)
    v_mfma_f32_16x16x32_bf16 v[24:27], v[160:163], v[80:83], v[24:27]
    v_mfma_f32_16x16x32_bf16 v[56:59], v[160:163], v[84:87], v[56:59]
    v_mfma_f32_16x16x32_bf16 v[28:31], v[164:167], v[80:83], v[28:31]
    v_mfma_f32_16x16x32_bf16 v[60:63], v[164:167], v[84:87], v[60:63]
    v_mfma_f32_16x16x32_bf16 v[32:35], v[168:171], v[80:83], v[32:35]
    v_mfma_f32_16x16x32_bf16 v[64:67], v[168:171], v[84:87], v[64:67]
    v_mfma_f32_16x16x32_bf16 v[36:39], v[172:175], v[80:83], v[36:39]
    v_mfma_f32_16x16x32_bf16 v[68:71], v[172:175], v[84:87], v[68:71]
    s_barrier
    v_mfma_f32_16x16x32_bf16 v[8:11], v[176:179], v[88:91], v[8:11]
    ds_read_b128 v[144:147], v4 offset:0
    v_mfma_f32_16x16x32_bf16 v[40:43], v[176:179], v[92:95], v[40:43]
    ds_read_b128 v[148:151], v4 offset:512
    v_mfma_f32_16x16x32_bf16 v[12:15], v[180:183], v[88:91], v[12:15]
    ds_read_b128 v[152:155], v4 offset:4224
    v_mfma_f32_16x16x32_bf16 v[44:47], v[180:183], v[92:95], v[44:47]
    ds_read_b128 v[156:159], v4 offset:4736
    v_mfma_f32_16x16x32_bf16 v[16:19], v[184:187], v[88:91], v[16:19]
    ds_read_b128 v[160:163], v4 offset:8448
    v_mfma_f32_16x16x32_bf16 v[48:51], v[184:187], v[92:95], v[48:51]
    ds_read_b128 v[164:167], v4 offset:8960
    v_mfma_f32_16x16x32_bf16 v[20:23], v[188:191], v[88:91], v[20:23]
    ds_read_b128 v[168:171], v4 offset:12672
    v_mfma_f32_16x16x32_bf16 v[52:55], v[188:191], v[92:95], v[52:55]
    ds_read_b128 v[172:175], v4 offset:13184
    s_waitcnt lgkmcnt(4)
    v_mfma_f32_16x16x32_bf16 v[24:27], v[192:195], v[88:91], v[24:27]
    v_mfma_f32_16x16x32_bf16 v[56:59], v[192:195], v[92:95], v[56:59]
    v_mfma_f32_16x16x32_bf16 v[28:31], v[196:199], v[88:91], v[28:31]
    v_mfma_f32_16x16x32_bf16 v[60:63], v[196:199], v[92:95], v[60:63]
    v_mfma_f32_16x16x32_bf16 v[32:35], v[200:203], v[88:91], v[32:35]
    v_mfma_f32_16x16x32_bf16 v[64:67], v[200:203], v[92:95], v[64:67]
    v_mfma_f32_16x16x32_bf16 v[36:39], v[204:207], v[88:91], v[36:39]
    v_mfma_f32_16x16x32_bf16 v[68:71], v[204:207], v[92:95], v[68:71]
    v_mfma_f32_16x16x32_bf16 v[8:11], v[144:147], v[96:99], v[8:11]
    ds_read_b128 v[176:179], v4 offset:64
    v_mfma_f32_16x16x32_bf16 v[40:43], v[144:147], v[100:103], v[40:43]
    ds_read_b128 v[180:183], v4 offset:576
    v_mfma_f32_16x16x32_bf16 v[12:15], v[148:151], v[96:99], v[12:15]
    ds_read_b128 v[184:187], v4 offset:4288
    v_mfma_f32_16x16x32_bf16 v[44:47], v[148:151], v[100:103], v[44:47]
    ds_read_b128 v[188:191], v4 offset:4800
    v_mfma_f32_16x16x32_bf16 v[16:19], v[152:155], v[96:99], v[16:19]
    ds_read_b128 v[192:195], v4 offset:8512
    v_mfma_f32_16x16x32_bf16 v[48:51], v[152:155], v[100:103], v[48:51]
    ds_read_b128 v[196:199], v4 offset:9024
    v_mfma_f32_16x16x32_bf16 v[20:23], v[156:159], v[96:99], v[20:23]
    ds_read_b128 v[200:203], v4 offset:12736
    v_mfma_f32_16x16x32_bf16 v[52:55], v[156:159], v[100:103], v[52:55]
    ds_read_b128 v[204:207], v4 offset:13248
    s_waitcnt lgkmcnt(4)
    v_mfma_f32_16x16x32_bf16 v[24:27], v[160:163], v[96:99], v[24:27]
    v_mfma_f32_16x16x32_bf16 v[56:59], v[160:163], v[100:103], v[56:59]
    v_mfma_f32_16x16x32_bf16 v[28:31], v[164:167], v[96:99], v[28:31]
    v_mfma_f32_16x16x32_bf16 v[60:63], v[164:167], v[100:103], v[60:63]
    v_mfma_f32_16x16x32_bf16 v[32:35], v[168:171], v[96:99], v[32:35]
    v_mfma_f32_16x16x32_bf16 v[64:67], v[168:171], v[100:103], v[64:67]
    v_mfma_f32_16x16x32_bf16 v[36:39], v[172:175], v[96:99], v[36:39]
    v_mfma_f32_16x16x32_bf16 v[68:71], v[172:175], v[100:103], v[68:71]
    s_barrier
    v_mfma_f32_16x16x32_bf16 v[8:11], v[176:179], v[104:107], v[8:11]
    ds_read_b128 v[144:147], v4 offset:16896
    v_mfma_f32_16x16x32_bf16 v[40:43], v[176:179], v[108:111], v[40:43]
    ds_read_b128 v[148:151], v4 offset:17408
    v_mfma_f32_16x16x32_bf16 v[12:15], v[180:183], v[104:107], v[12:15]
    ds_read_b128 v[152:155], v4 offset:21120
    v_mfma_f32_16x16x32_bf16 v[44:47], v[180:183], v[108:111], v[44:47]
    ds_read_b128 v[156:159], v4 offset:21632
    v_mfma_f32_16x16x32_bf16 v[16:19], v[184:187], v[104:107], v[16:19]
    ds_read_b128 v[160:163], v4 offset:25344
    v_mfma_f32_16x16x32_bf16 v[48:51], v[184:187], v[108:111], v[48:51]
    ds_read_b128 v[164:167], v4 offset:25856
    v_mfma_f32_16x16x32_bf16 v[20:23], v[188:191], v[104:107], v[20:23]
    ds_read_b128 v[168:171], v4 offset:29568
    v_mfma_f32_16x16x32_bf16 v[52:55], v[188:191], v[108:111], v[52:55]
    ds_read_b128 v[172:175], v4 offset:30080
    s_waitcnt lgkmcnt(4)
    v_mfma_f32_16x16x32_bf16 v[24:27], v[192:195], v[104:107], v[24:27]
    v_mfma_f32_16x16x32_bf16 v[56:59], v[192:195], v[108:111], v[56:59]
    v_mfma_f32_16x16x32_bf16 v[28:31], v[196:199], v[104:107], v[28:31]
    v_mfma_f32_16x16x32_bf16 v[60:63], v[196:199], v[108:111], v[60:63]
    v_mfma_f32_16x16x32_bf16 v[32:35], v[200:203], v[104:107], v[32:35]
    v_mfma_f32_16x16x32_bf16 v[64:67], v[200:203], v[108:111], v[64:67]
    v_mfma_f32_16x16x32_bf16 v[36:39], v[204:207], v[104:107], v[36:39]
    v_mfma_f32_16x16x32_bf16 v[68:71], v[204:207], v[108:111], v[68:71]
    v_mfma_f32_16x16x32_bf16 v[8:11], v[144:147], v[112:115], v[8:11]
    ds_read_b128 v[176:179], v4 offset:16960
    v_mfma_f32_16x16x32_bf16 v[40:43], v[144:147], v[116:119], v[40:43]
    ds_read_b128 v[180:183], v4 offset:17472
    v_mfma_f32_16x16x32_bf16 v[12:15], v[148:151], v[112:115], v[12:15]
    ds_read_b128 v[184:187], v4 offset:21184
    v_mfma_f32_16x16x32_bf16 v[44:47], v[148:151], v[116:119], v[44:47]
    ds_read_b128 v[188:191], v4 offset:21696
    v_mfma_f32_16x16x32_bf16 v[16:19], v[152:155], v[112:115], v[16:19]
    ds_read_b128 v[192:195], v4 offset:25408
    v_mfma_f32_16x16x32_bf16 v[48:51], v[152:155], v[116:119], v[48:51]
    ds_read_b128 v[196:199], v4 offset:25920
    v_mfma_f32_16x16x32_bf16 v[20:23], v[156:159], v[112:115], v[20:23]
    ds_read_b128 v[200:203], v4 offset:29632
    v_mfma_f32_16x16x32_bf16 v[52:55], v[156:159], v[116:119], v[52:55]
    ds_read_b128 v[204:207], v4 offset:30144
    s_waitcnt lgkmcnt(4)
    v_mfma_f32_16x16x32_bf16 v[24:27], v[160:163], v[112:115], v[24:27]
    v_mfma_f32_16x16x32_bf16 v[56:59], v[160:163], v[116:119], v[56:59]
    v_mfma_f32_16x16x32_bf16 v[28:31], v[164:167], v[112:115], v[28:31]
    v_mfma_f32_16x16x32_bf16 v[60:63], v[164:167], v[116:119], v[60:63]
    v_mfma_f32_16x16x32_bf16 v[32:35], v[168:171], v[112:115], v[32:35]
    v_mfma_f32_16x16x32_bf16 v[64:67], v[168:171], v[116:119], v[64:67]
    v_mfma_f32_16x16x32_bf16 v[36:39], v[172:175], v[112:115], v[36:39]
    v_mfma_f32_16x16x32_bf16 v[68:71], v[172:175], v[116:119], v[68:71]
    s_barrier
    v_mfma_f32_16x16x32_bf16 v[8:11], v[176:179], v[120:123], v[8:11]
    ds_read_b128 v[144:147], v4 offset:33792
    v_mfma_f32_16x16x32_bf16 v[40:43], v[176:179], v[124:127], v[40:43]
    ds_read_b128 v[148:151], v4 offset:34304
    v_mfma_f32_16x16x32_bf16 v[12:15], v[180:183], v[120:123], v[12:15]
    ds_read_b128 v[152:155], v4 offset:38016
    v_mfma_f32_16x16x32_bf16 v[44:47], v[180:183], v[124:127], v[44:47]
    ds_read_b128 v[156:159], v4 offset:38528
    v_mfma_f32_16x16x32_bf16 v[16:19], v[184:187], v[120:123], v[16:19]
    ds_read_b128 v[160:163], v4 offset:42240
    v_mfma_f32_16x16x32_bf16 v[48:51], v[184:187], v[124:127], v[48:51]
    ds_read_b128 v[164:167], v4 offset:42752
    v_mfma_f32_16x16x32_bf16 v[20:23], v[188:191], v[120:123], v[20:23]
    ds_read_b128 v[168:171], v4 offset:46464
    v_mfma_f32_16x16x32_bf16 v[52:55], v[188:191], v[124:127], v[52:55]
    ds_read_b128 v[172:175], v4 offset:46976
    s_waitcnt lgkmcnt(4)
    v_mfma_f32_16x16x32_bf16 v[24:27], v[192:195], v[120:123], v[24:27]
    v_mfma_f32_16x16x32_bf16 v[56:59], v[192:195], v[124:127], v[56:59]
    v_mfma_f32_16x16x32_bf16 v[28:31], v[196:199], v[120:123], v[28:31]
    v_mfma_f32_16x16x32_bf16 v[60:63], v[196:199], v[124:127], v[60:63]
    v_mfma_f32_16x16x32_bf16 v[32:35], v[200:203], v[120:123], v[32:35]
    v_mfma_f32_16x16x32_bf16 v[64:67], v[200:203], v[124:127], v[64:67]
    v_mfma_f32_16x16x32_bf16 v[36:39], v[204:207], v[120:123], v[36:39]
    v_mfma_f32_16x16x32_bf16 v[68:71], v[204:207], v[124:127], v[68:71]
    v_mfma_f32_16x16x32_bf16 v[8:11], v[144:147], v[128:131], v[8:11]
    ds_read_b128 v[176:179], v4 offset:33856
    v_mfma_f32_16x16x32_bf16 v[40:43], v[144:147], v[132:135], v[40:43]
    ds_read_b128 v[180:183], v4 offset:34368
    v_mfma_f32_16x16x32_bf16 v[12:15], v[148:151], v[128:131], v[12:15]
    ds_read_b128 v[184:187], v4 offset:38080
    v_mfma_f32_16x16x32_bf16 v[44:47], v[148:151], v[132:135], v[44:47]
    ds_read_b128 v[188:191], v4 offset:38592
    v_mfma_f32_16x16x32_bf16 v[16:19], v[152:155], v[128:131], v[16:19]
    ds_read_b128 v[192:195], v4 offset:42304
    v_mfma_f32_16x16x32_bf16 v[48:51], v[152:155], v[132:135], v[48:51]
    ds_read_b128 v[196:199], v4 offset:42816
    v_mfma_f32_16x16x32_bf16 v[20:23], v[156:159], v[128:131], v[20:23]
    ds_read_b128 v[200:203], v4 offset:46528
    v_mfma_f32_16x16x32_bf16 v[52:55], v[156:159], v[132:135], v[52:55]
    ds_read_b128 v[204:207], v4 offset:47040
    s_waitcnt lgkmcnt(4)
    v_mfma_f32_16x16x32_bf16 v[24:27], v[160:163], v[128:131], v[24:27]
    v_mfma_f32_16x16x32_bf16 v[56:59], v[160:163], v[132:135], v[56:59]
    v_mfma_f32_16x16x32_bf16 v[28:31], v[164:167], v[128:131], v[28:31]
    v_mfma_f32_16x16x32_bf16 v[60:63], v[164:167], v[132:135], v[60:63]
    v_mfma_f32_16x16x32_bf16 v[32:35], v[168:171], v[128:131], v[32:35]
    v_mfma_f32_16x16x32_bf16 v[64:67], v[168:171], v[132:135], v[64:67]
    v_mfma_f32_16x16x32_bf16 v[36:39], v[172:175], v[128:131], v[36:39]
    v_mfma_f32_16x16x32_bf16 v[68:71], v[172:175], v[132:135], v[68:71]
    v_mfma_f32_16x16x32_bf16 v[8:11], v[176:179], v[136:139], v[8:11]
    v_mfma_f32_16x16x32_bf16 v[40:43], v[176:179], v[140:143], v[40:43]
    v_mfma_f32_16x16x32_bf16 v[12:15], v[180:183], v[136:139], v[12:15]
    v_mfma_f32_16x16x32_bf16 v[44:47], v[180:183], v[140:143], v[44:47]
    v_mfma_f32_16x16x32_bf16 v[16:19], v[184:187], v[136:139], v[16:19]
    v_mfma_f32_16x16x32_bf16 v[48:51], v[184:187], v[140:143], v[48:51]
    v_mfma_f32_16x16x32_bf16 v[20:23], v[188:191], v[136:139], v[20:23]
    v_mfma_f32_16x16x32_bf16 v[52:55], v[188:191], v[140:143], v[52:55]
    s_waitcnt lgkmcnt(3)
    v_mfma_f32_16x16x32_bf16 v[24:27], v[192:195], v[136:139], v[24:27]
    v_mfma_f32_16x16x32_bf16 v[56:59], v[192:195], v[140:143], v[56:59]
    s_waitcnt lgkmcnt(2)
    v_mfma_f32_16x16x32_bf16 v[28:31], v[196:199], v[136:139], v[28:31]
    v_mfma_f32_16x16x32_bf16 v[60:63], v[196:199], v[140:143], v[60:63]
    s_waitcnt lgkmcnt(1)
    v_mfma_f32_16x16x32_bf16 v[32:35], v[200:203], v[136:139], v[32:35]
    v_mfma_f32_16x16x32_bf16 v[64:67], v[200:203], v[140:143], v[64:67]
    s_waitcnt lgkmcnt(0)
    v_mfma_f32_16x16x32_bf16 v[36:39], v[204:207], v[136:139], v[36:39]
    v_mfma_f32_16x16x32_bf16 v[68:71], v[204:207], v[140:143], v[68:71]
    s_mul_i32 s6, s32, 4608
    v_mul_u32_u24 v5, 147456, v241
    v_lshl_add_u32 v5, v242, 4, v5
    v_add_u32 v5, s6, v5
    v_cvt_pk_bf16_f32 v144, v8, v9
    v_cvt_pk_bf16_f32 v145, v10, v11
    v_cvt_pk_bf16_f32 v146, v12, v13
    v_cvt_pk_bf16_f32 v147, v14, v15
    v_cvt_pk_bf16_f32 v148, v16, v17
    v_cvt_pk_bf16_f32 v149, v18, v19
    v_cvt_pk_bf16_f32 v150, v20, v21
    v_cvt_pk_bf16_f32 v151, v22, v23
    v_cvt_pk_bf16_f32 v152, v24, v25
    v_cvt_pk_bf16_f32 v153, v26, v27
    v_cvt_pk_bf16_f32 v154, v28, v29
    v_cvt_pk_bf16_f32 v155, v30, v31
    v_cvt_pk_bf16_f32 v156, v32, v33
    v_cvt_pk_bf16_f32 v157, v34, v35
    v_cvt_pk_bf16_f32 v158, v36, v37
    v_cvt_pk_bf16_f32 v159, v38, v39
    v_cvt_pk_bf16_f32 v160, v40, v41
    v_cvt_pk_bf16_f32 v161, v42, v43
    v_cvt_pk_bf16_f32 v162, v44, v45
    v_cvt_pk_bf16_f32 v163, v46, v47
    v_cvt_pk_bf16_f32 v164, v48, v49
    v_cvt_pk_bf16_f32 v165, v50, v51
    v_cvt_pk_bf16_f32 v166, v52, v53
    v_cvt_pk_bf16_f32 v167, v54, v55
    v_cvt_pk_bf16_f32 v168, v56, v57
    v_cvt_pk_bf16_f32 v169, v58, v59
    v_cvt_pk_bf16_f32 v170, v60, v61
    v_cvt_pk_bf16_f32 v171, v62, v63
    v_cvt_pk_bf16_f32 v172, v64, v65
    v_cvt_pk_bf16_f32 v173, v66, v67
    v_cvt_pk_bf16_f32 v174, v68, v69
    v_cvt_pk_bf16_f32 v175, v70, v71
    v_mfma_f32_16x16x32_bf16 v[72:75], v[208:211], v[144:147], 0
    v_mfma_f32_16x16x32_bf16 v[76:79], v[208:211], v[152:155], 0
    v_mfma_f32_16x16x32_bf16 v[80:83], v[208:211], v[160:163], 0
    v_mfma_f32_16x16x32_bf16 v[84:87], v[208:211], v[168:171], 0
    v_mfma_f32_16x16x32_bf16 v[72:75], v[212:215], v[148:151], v[72:75]
    v_mfma_f32_16x16x32_bf16 v[76:79], v[212:215], v[156:159], v[76:79]
    v_mfma_f32_16x16x32_bf16 v[80:83], v[212:215], v[164:167], v[80:83]
    v_mfma_f32_16x16x32_bf16 v[84:87], v[212:215], v[172:175], v[84:87]
    v_mfma_f32_16x16x32_bf16 v[88:91], v[216:219], v[144:147], 0
    v_mfma_f32_16x16x32_bf16 v[92:95], v[216:219], v[152:155], 0
    v_mfma_f32_16x16x32_bf16 v[96:99], v[216:219], v[160:163], 0
    v_mfma_f32_16x16x32_bf16 v[100:103], v[216:219], v[168:171], 0
    v_mfma_f32_16x16x32_bf16 v[88:91], v[220:223], v[148:151], v[88:91]
    v_mfma_f32_16x16x32_bf16 v[92:95], v[220:223], v[156:159], v[92:95]
    v_mfma_f32_16x16x32_bf16 v[96:99], v[220:223], v[164:167], v[96:99]
    v_mfma_f32_16x16x32_bf16 v[100:103], v[220:223], v[172:175], v[100:103]
    v_cvt_pk_bf16_f32 v8, v72, v76
    v_cvt_pk_bf16_f32 v9, v73, v77
    v_cvt_pk_bf16_f32 v10, v80, v84
    v_cvt_pk_bf16_f32 v11, v81, v85
    v_min_u32 v8, -2, v8
    s_mov_b32 s6, 0
    buffer_store_dwordx4 v[8:11], v5, s[24:27], s6 offen sc1
    v_cvt_pk_bf16_f32 v12, v74, v78
    v_cvt_pk_bf16_f32 v13, v75, v79
    v_cvt_pk_bf16_f32 v14, v82, v86
    v_cvt_pk_bf16_f32 v15, v83, v87
    v_min_u32 v12, -2, v12
    s_mov_b32 s6, 73728
    buffer_store_dwordx4 v[12:15], v5, s[24:27], s6 offen sc1
    v_mfma_f32_16x16x32_bf16 v[104:107], v[224:227], v[144:147], 0
    v_mfma_f32_16x16x32_bf16 v[108:111], v[224:227], v[152:155], 0
    v_mfma_f32_16x16x32_bf16 v[112:115], v[224:227], v[160:163], 0
    v_mfma_f32_16x16x32_bf16 v[116:119], v[224:227], v[168:171], 0
    v_mfma_f32_16x16x32_bf16 v[104:107], v[228:231], v[148:151], v[104:107]
    v_mfma_f32_16x16x32_bf16 v[108:111], v[228:231], v[156:159], v[108:111]
    v_mfma_f32_16x16x32_bf16 v[112:115], v[228:231], v[164:167], v[112:115]
    v_mfma_f32_16x16x32_bf16 v[116:119], v[228:231], v[172:175], v[116:119]
    v_cvt_pk_bf16_f32 v16, v88, v92
    v_cvt_pk_bf16_f32 v17, v89, v93
    v_cvt_pk_bf16_f32 v18, v96, v100
    v_cvt_pk_bf16_f32 v19, v97, v101
    v_min_u32 v16, -2, v16
    s_mov_b32 s6, 589824
    buffer_store_dwordx4 v[16:19], v5, s[24:27], s6 offen sc1
    v_cvt_pk_bf16_f32 v20, v90, v94
    v_cvt_pk_bf16_f32 v21, v91, v95
    v_cvt_pk_bf16_f32 v22, v98, v102
    v_cvt_pk_bf16_f32 v23, v99, v103
    v_min_u32 v20, -2, v20
    s_mov_b32 s6, 663552
    buffer_store_dwordx4 v[20:23], v5, s[24:27], s6 offen sc1
    v_mfma_f32_16x16x32_bf16 v[120:123], v[232:235], v[144:147], 0
    v_mfma_f32_16x16x32_bf16 v[124:127], v[232:235], v[152:155], 0
    v_mfma_f32_16x16x32_bf16 v[128:131], v[232:235], v[160:163], 0
    v_mfma_f32_16x16x32_bf16 v[132:135], v[232:235], v[168:171], 0
    v_mfma_f32_16x16x32_bf16 v[120:123], v[236:239], v[148:151], v[120:123]
    v_mfma_f32_16x16x32_bf16 v[124:127], v[236:239], v[156:159], v[124:127]
    v_mfma_f32_16x16x32_bf16 v[128:131], v[236:239], v[164:167], v[128:131]
    v_mfma_f32_16x16x32_bf16 v[132:135], v[236:239], v[172:175], v[132:135]
    v_cvt_pk_bf16_f32 v24, v104, v108
    v_cvt_pk_bf16_f32 v25, v105, v109
    v_cvt_pk_bf16_f32 v26, v112, v116
    v_cvt_pk_bf16_f32 v27, v113, v117
    v_min_u32 v24, -2, v24
    s_mov_b32 s6, 1179648
    buffer_store_dwordx4 v[24:27], v5, s[24:27], s6 offen sc1
    v_cvt_pk_bf16_f32 v28, v106, v110
    v_cvt_pk_bf16_f32 v29, v107, v111
    v_cvt_pk_bf16_f32 v30, v114, v118
    v_cvt_pk_bf16_f32 v31, v115, v119
    v_min_u32 v28, -2, v28
    s_mov_b32 s6, 1253376
    buffer_store_dwordx4 v[28:31], v5, s[24:27], s6 offen sc1
    v_cvt_pk_bf16_f32 v32, v120, v124
    v_cvt_pk_bf16_f32 v33, v121, v125
    v_cvt_pk_bf16_f32 v34, v128, v132
    v_cvt_pk_bf16_f32 v35, v129, v133
    v_min_u32 v32, -2, v32
    s_mov_b32 s6, 1769472
    buffer_store_dwordx4 v[32:35], v5, s[24:27], s6 offen sc1
    v_cvt_pk_bf16_f32 v36, v122, v126
    v_cvt_pk_bf16_f32 v37, v123, v127
    v_cvt_pk_bf16_f32 v38, v130, v134
    v_cvt_pk_bf16_f32 v39, v131, v135
    v_min_u32 v36, -2, v36
    s_mov_b32 s6, 1843200
    buffer_store_dwordx4 v[36:39], v5, s[24:27], s6 offen sc1
    v_lshlrev_b32 v248, 7, v0
    s_mov_b32 s53, 12599296
    s_mov_b32 s54, 12603392
    buffer_load_dword v249, off, s[28:31], 0 sc1
    buffer_load_dword v250, v248, s[24:27], s53 offen sc1
    buffer_load_dword v251, v248, s[24:27], s54 offen sc1
    s_mul_i32 s42, s40, 43
    s_lshr_b32 s42, s42, 7
    s_mul_i32 s6, s42, 3
    s_sub_u32 s43, s40, s6
    s_mul_i32 s43, s43, 3
    s_add_u32 s43, s43, s3
    v_lshlrev_b32 v3, 3, v241
    v_cvt_f32_u32 v3, v3
    s_mov_b32 s44, 0x80008000
    v_lshl_add_u32 v1, v240, 6, s42
    v_cvt_f32_u32 v1, v1
    v_mul_f32 v1, 0x3a000000, v1
    v_mul_f32 v136, v3, v1
    v_add_f32 v137, v136, v1
    v_add_f32 v138, v137, v1
    v_add_f32 v139, v138, v1
    v_add_f32 v140, v139, v1
    v_add_f32 v141, v140, v1
    v_add_f32 v142, v141, v1
    v_add_f32 v143, v142, v1
    v_cos_f32 v144, v136
    v_cos_f32 v145, v137
    v_cos_f32 v146, v138
    v_cos_f32 v147, v139
    v_cos_f32 v148, v140
    v_cos_f32 v149, v141
    v_cos_f32 v150, v142
    v_cos_f32 v151, v143
    v_sin_f32 v136, v136
    v_sin_f32 v137, v137
    v_sin_f32 v138, v138
    v_sin_f32 v139, v139
    v_sin_f32 v140, v140
    v_sin_f32 v141, v141
    v_sin_f32 v142, v142
    v_sin_f32 v143, v143
    v_cvt_pk_bf16_f32 v200, v144, v145
    v_cvt_pk_bf16_f32 v201, v146, v147
    v_cvt_pk_bf16_f32 v202, v148, v149
    v_cvt_pk_bf16_f32 v203, v150, v151
    v_cvt_pk_bf16_f32 v204, v136, v137
    v_cvt_pk_bf16_f32 v205, v138, v139
    v_cvt_pk_bf16_f32 v206, v140, v141
    v_cvt_pk_bf16_f32 v207, v142, v143
    v_add_f32 v1, 0.5, v1
    v_mul_f32 v136, v3, v1
    v_add_f32 v137, v136, v1
    v_add_f32 v138, v137, v1
    v_add_f32 v139, v138, v1
    v_add_f32 v140, v139, v1
    v_add_f32 v141, v140, v1
    v_add_f32 v142, v141, v1
    v_add_f32 v143, v142, v1
    v_cos_f32 v144, v136
    v_cos_f32 v145, v137
    v_cos_f32 v146, v138
    v_cos_f32 v147, v139
    v_cos_f32 v148, v140
    v_cos_f32 v149, v141
    v_cos_f32 v150, v142
    v_cos_f32 v151, v143
    v_sin_f32 v136, v136
    v_sin_f32 v137, v137
    v_sin_f32 v138, v138
    v_sin_f32 v139, v139
    v_sin_f32 v140, v140
    v_sin_f32 v141, v141
    v_sin_f32 v142, v142
    v_sin_f32 v143, v143
    v_cvt_pk_bf16_f32 v208, v144, v145
    v_cvt_pk_bf16_f32 v209, v146, v147
    v_cvt_pk_bf16_f32 v210, v148, v149
    v_cvt_pk_bf16_f32 v211, v150, v151
    v_cvt_pk_bf16_f32 v212, v136, v137
    v_cvt_pk_bf16_f32 v213, v138, v139
    v_cvt_pk_bf16_f32 v214, v140, v141
    v_cvt_pk_bf16_f32 v215, v142, v143
    v_mov_b32 v72, v200
    v_mov_b32 v73, v204
    v_mov_b32 v74, v204
    v_xor_b32 v75, s44, v200
    v_mov_b32 v104, v200
    v_mov_b32 v105, v204
    v_xor_b32 v106, s44, v204
    v_mov_b32 v107, v200
    v_mov_b32 v76, v201
    v_mov_b32 v77, v205
    v_mov_b32 v78, v205
    v_xor_b32 v79, s44, v201
    v_mov_b32 v108, v201
    v_mov_b32 v109, v205
    v_xor_b32 v110, s44, v205
    v_mov_b32 v111, v201
    v_mov_b32 v80, v202
    v_mov_b32 v81, v206
    v_mov_b32 v82, v206
    v_xor_b32 v83, s44, v202
    v_mov_b32 v112, v202
    v_mov_b32 v113, v206
    v_xor_b32 v114, s44, v206
    v_mov_b32 v115, v202
    v_mov_b32 v84, v203
    v_mov_b32 v85, v207
    v_mov_b32 v86, v207
    v_xor_b32 v87, s44, v203
    v_mov_b32 v116, v203
    v_mov_b32 v117, v207
    v_xor_b32 v118, s44, v207
    v_mov_b32 v119, v203
    v_mov_b32 v88, v208
    v_mov_b32 v89, v212
    v_mov_b32 v90, v212
    v_xor_b32 v91, s44, v208
    v_mov_b32 v120, v208
    v_mov_b32 v121, v212
    v_xor_b32 v122, s44, v212
    v_mov_b32 v123, v208
    v_mov_b32 v92, v209
    v_mov_b32 v93, v213
    v_mov_b32 v94, v213
    v_xor_b32 v95, s44, v209
    v_mov_b32 v124, v209
    v_mov_b32 v125, v213
    v_xor_b32 v126, s44, v213
    v_mov_b32 v127, v209
    v_mov_b32 v96, v210
    v_mov_b32 v97, v214
    v_mov_b32 v98, v214
    v_xor_b32 v99, s44, v210
    v_mov_b32 v128, v210
    v_mov_b32 v129, v214
    v_xor_b32 v130, s44, v214
    v_mov_b32 v131, v210
    v_mov_b32 v100, v211
    v_mov_b32 v101, v215
    v_mov_b32 v102, v215
    v_xor_b32 v103, s44, v211
    v_mov_b32 v132, v211
    v_mov_b32 v133, v215
    v_xor_b32 v134, s44, v215
    v_mov_b32 v135, v211
    s_mov_b32 s45, s42
    s_cmp_lg_u32 s42, 0
    s_cbranch_scc1 L_Ac2
    s_mov_b32 s45, 32
    v_lshl_add_u32 v1, v240, 6, 32
    v_cvt_f32_u32 v1, v1
    v_mul_f32 v1, 0x3a000000, v1
    v_mul_f32 v136, v3, v1
    v_add_f32 v137, v136, v1
    v_add_f32 v138, v137, v1
    v_add_f32 v139, v138, v1
    v_add_f32 v140, v139, v1
    v_add_f32 v141, v140, v1
    v_add_f32 v142, v141, v1
    v_add_f32 v143, v142, v1
    v_cos_f32 v144, v136
    v_cos_f32 v145, v137
    v_cos_f32 v146, v138
    v_cos_f32 v147, v139
    v_cos_f32 v148, v140
    v_cos_f32 v149, v141
    v_cos_f32 v150, v142
    v_cos_f32 v151, v143
    v_sin_f32 v136, v136
    v_sin_f32 v137, v137
    v_sin_f32 v138, v138
    v_sin_f32 v139, v139
    v_sin_f32 v140, v140
    v_sin_f32 v141, v141
    v_sin_f32 v142, v142
    v_sin_f32 v143, v143
    v_cvt_pk_bf16_f32 v200, v144, v145
    v_cvt_pk_bf16_f32 v201, v146, v147
    v_cvt_pk_bf16_f32 v202, v148, v149
    v_cvt_pk_bf16_f32 v203, v150, v151
    v_cvt_pk_bf16_f32 v204, v136, v137
    v_cvt_pk_bf16_f32 v205, v138, v139
    v_cvt_pk_bf16_f32 v206, v140, v141
    v_cvt_pk_bf16_f32 v207, v142, v143
    v_add_f32 v1, 0.5, v1
    v_mul_f32 v136, v3, v1
    v_add_f32 v137, v136, v1
    v_add_f32 v138, v137, v1
    v_add_f32 v139, v138, v1
    v_add_f32 v140, v139, v1
    v_add_f32 v141, v140, v1
    v_add_f32 v142, v141, v1
    v_add_f32 v143, v142, v1
    v_cos_f32 v144, v136
    v_cos_f32 v145, v137
    v_cos_f32 v146, v138
    v_cos_f32 v147, v139
    v_cos_f32 v148, v140
    v_cos_f32 v149, v141
    v_cos_f32 v150, v142
    v_cos_f32 v151, v143
    v_sin_f32 v136, v136
    v_sin_f32 v137, v137
    v_sin_f32 v138, v138
    v_sin_f32 v139, v139
    v_sin_f32 v140, v140
    v_sin_f32 v141, v141
    v_sin_f32 v142, v142
    v_sin_f32 v143, v143
    v_cvt_pk_bf16_f32 v208, v144, v145
    v_cvt_pk_bf16_f32 v209, v146, v147
    v_cvt_pk_bf16_f32 v210, v148, v149
    v_cvt_pk_bf16_f32 v211, v150, v151
    v_cvt_pk_bf16_f32 v212, v136, v137
    v_cvt_pk_bf16_f32 v213, v138, v139
    v_cvt_pk_bf16_f32 v214, v140, v141
    v_cvt_pk_bf16_f32 v215, v142, v143
    v_mov_b32 v73, 0
    v_mov_b32 v75, 0
    v_mov_b32 v104, 0
    v_mov_b32 v105, v200
    v_mov_b32 v106, 0
    v_xor_b32 v107, s44, v204
    v_mov_b32 v77, 0
    v_mov_b32 v79, 0
    v_mov_b32 v108, 0
    v_mov_b32 v109, v201
    v_mov_b32 v110, 0
    v_xor_b32 v111, s44, v205
    v_mov_b32 v81, 0
    v_mov_b32 v83, 0
    v_mov_b32 v112, 0
    v_mov_b32 v113, v202
    v_mov_b32 v114, 0
    v_xor_b32 v115, s44, v206
    v_mov_b32 v85, 0
    v_mov_b32 v87, 0
    v_mov_b32 v116, 0
    v_mov_b32 v117, v203
    v_mov_b32 v118, 0
    v_xor_b32 v119, s44, v207
    v_mov_b32 v89, 0
    v_mov_b32 v91, 0
    v_mov_b32 v120, 0
    v_mov_b32 v121, v208
    v_mov_b32 v122, 0
    v_xor_b32 v123, s44, v212
    v_mov_b32 v93, 0
    v_mov_b32 v95, 0
    v_mov_b32 v124, 0
    v_mov_b32 v125, v209
    v_mov_b32 v126, 0
    v_xor_b32 v127, s44, v213
    v_mov_b32 v97, 0
    v_mov_b32 v99, 0
    v_mov_b32 v128, 0
    v_mov_b32 v129, v210
    v_mov_b32 v130, 0
    v_xor_b32 v131, s44, v214
    v_mov_b32 v101, 0
    v_mov_b32 v103, 0
    v_mov_b32 v132, 0
    v_mov_b32 v133, v211
    v_mov_b32 v134, 0
    v_xor_b32 v135, s44, v215
L_Ac2:
    s_lshl_b32 s6, s43, 6
    v_lshl_add_u32 v1, v240, 2, s6
    v_mul_u32_u24 v2, 18432, v241
    s_movk_i32 s7, 288
    v_cmp_gt_u32 s[46:47], s7, v1
    v_cmp_eq_u32 s[48:49], s7, v1
    v_cmp_eq_u32 s[50:51], 0, v1
    v_add_u32 v3, 0, v1
    v_sub_u32 v4, 576, v3
    v_cndmask_b32 v3, v4, v3, s[46:47]
    v_cndmask_b32 v3, v3, 0, s[48:49]
    v_and_b32 v4, 3, v3
    v_lshrrev_b32 v3, 2, v3
    v_mul_u32_u24 v4, 72, v4
    v_add_u32 v3, v3, v4
    v_lshl_add_u32 v232, v3, 4, v2
    v_add_u32 v3, 1, v1
    v_sub_u32 v4, 576, v3
    v_cndmask_b32 v3, v4, v3, s[46:47]
    v_and_b32 v4, 3, v3
    v_lshrrev_b32 v3, 2, v3
    v_mul_u32_u24 v4, 72, v4
    v_add_u32 v3, v3, v4
    v_lshl_add_u32 v233, v3, 4, v2
    v_add_u32 v3, 2, v1
    v_sub_u32 v4, 576, v3
    v_cndmask_b32 v3, v4, v3, s[46:47]
    v_and_b32 v4, 3, v3
    v_lshrrev_b32 v3, 2, v3
    v_mul_u32_u24 v4, 72, v4
    v_add_u32 v3, v3, v4
    v_lshl_add_u32 v234, v3, 4, v2
    v_add_u32 v3, 3, v1
    v_sub_u32 v4, 576, v3
    v_cndmask_b32 v3, v4, v3, s[46:47]
    v_and_b32 v4, 3, v3
    v_lshrrev_b32 v3, 2, v3
    v_mul_u32_u24 v4, 72, v4
    v_add_u32 v3, v3, v4
    v_lshl_add_u32 v235, v3, 4, v2
    s_or_b64 s[50:51], s[50:51], s[48:49]
    v_lshlrev_b32 v1, 1, v1
    v_lshlrev_b32 v2, 8, v241
    v_add_u32 v3, s42, v2
    v_sub_u32 v4, 2048, v3
    v_cndmask_b32 v3, v4, v3, s[46:47]
    v_add_u32 v5, s45, v2
    v_sub_u32 v4, 2048, v5
    v_cndmask_b32 v5, v5, v4, s[46:47]
    v_mov_b32 v6, 147456
    v_mov_b32 v7, 4294819840
    v_cndmask_b32 v6, v7, v6, s[46:47]
    v_lshlrev_b32 v7, 4, v6
    s_movk_i32 s6, 2304
    v_mad_u32_u24 v216, v3, s6, v1
    v_mad_u32_u24 v224, v5, s6, v1
    v_add_u32 v217, v216, v6
    v_sub_u32 v225, v224, v6
    v_add_u32 v218, v217, v6
    v_sub_u32 v226, v225, v6
    v_add_u32 v219, v218, v6
    v_sub_u32 v227, v226, v6
    v_add_u32 v220, v216, v7
    v_sub_u32 v228, v224, v7
    v_add_u32 v221, v217, v7
    v_sub_u32 v229, v225, v7
    v_add_u32 v222, v218, v7
    v_sub_u32 v230, v226, v7
    v_add_u32 v223, v219, v7
    v_sub_u32 v231, v227, v7
    v_and_b32 v3, 2047, v3
    v_mad_u32_u24 v216, v3, s6, v1
    s_mul_i32 s52, s42, 73728
    s_movk_i32 s5, 3750
    s_add_u32 s56, s52, 0
    s_add_u32 s57, s52, 4608
    s_add_u32 s58, s52, 9216
    s_add_u32 s59, s52, 13824
    s_waitcnt vmcnt(0)
L_An:
    v_cmp_ne_u32 vcc, v250, v249
    v_cmp_ne_u32 s[6:7], v251, v249
    s_or_b64 vcc, vcc, s[6:7]
    v_cmp_le_i32 s[6:7], 0, v249
    s_or_b64 vcc, vcc, s[6:7]
    s_cbranch_scc0 L_And
    s_sleep 8
    buffer_load_dword v249, off, s[28:31], 0 sc1
    buffer_load_dword v250, v248, s[24:27], s53 offen sc1
    buffer_load_dword v251, v248, s[24:27], s54 offen sc1
    s_sub_u32 s5, s5, 1
    s_waitcnt vmcnt(0)
    s_cbranch_scc0 L_An
L_And:
    s_movk_i32 s5, 30000
    buffer_load_dwordx4 v[136:139], v232, s[24:27], s56 offen sc1
    buffer_load_dwordx4 v[140:143], v233, s[24:27], s56 offen sc1
    buffer_load_dwordx4 v[144:147], v234, s[24:27], s56 offen sc1
    buffer_load_dwordx4 v[148:151], v235, s[24:27], s56 offen sc1
    buffer_load_dwordx4 v[152:155], v232, s[24:27], s57 offen sc1
    buffer_load_dwordx4 v[156:159], v233, s[24:27], s57 offen sc1
    buffer_load_dwordx4 v[160:163], v234, s[24:27], s57 offen sc1
    buffer_load_dwordx4 v[164:167], v235, s[24:27], s57 offen sc1
    buffer_load_dwordx4 v[168:171], v232, s[24:27], s58 offen sc1
    buffer_load_dwordx4 v[172:175], v233, s[24:27], s58 offen sc1
    buffer_load_dwordx4 v[176:179], v234, s[24:27], s58 offen sc1
    buffer_load_dwordx4 v[180:183], v235, s[24:27], s58 offen sc1
    buffer_load_dwordx4 v[184:187], v232, s[24:27], s59 offen sc1
    buffer_load_dwordx4 v[188:191], v233, s[24:27], s59 offen sc1
    buffer_load_dwordx4 v[192:195], v234, s[24:27], s59 offen sc1
    buffer_load_dwordx4 v[196:199], v235, s[24:27], s59 offen sc1
    s_waitcnt vmcnt(12)
L_Ak0:
    v_max3_u32 v1, v136, v140, v144
    v_max_u32 v1, v1, v148
    v_cmp_eq_u32 vcc, -1, v1
    s_cbranch_vccnz L_Ak0r
L_Ak0d:
    v_cndmask_b32 v136, v136, v138, s[48:49]
    v_cndmask_b32 v137, v137, v139, s[48:49]
    v_cndmask_b32 v138, v138, 0, s[50:51]
    v_cndmask_b32 v139, v139, 0, s[50:51]
    v_mfma_f32_16x16x32_bf16 v[12:15], v[72:75], v[140:143], 0
    v_mfma_f32_16x16x32_bf16 v[16:19], v[72:75], v[144:147], 0
    v_mfma_f32_16x16x32_bf16 v[20:23], v[72:75], v[148:151], 0
    v_mfma_f32_16x16x32_bf16 v[8:11], v[72:75], v[136:139], 0
    v_mfma_f32_16x16x32_bf16 v[28:31], v[88:91], v[140:143], 0
    v_mfma_f32_16x16x32_bf16 v[32:35], v[88:91], v[144:147], 0
    v_mfma_f32_16x16x32_bf16 v[36:39], v[88:91], v[148:151], 0
    v_mfma_f32_16x16x32_bf16 v[24:27], v[88:91], v[136:139], 0
    v_mfma_f32_16x16x32_bf16 v[44:47], v[104:107], v[140:143], 0
    v_mfma_f32_16x16x32_bf16 v[48:51], v[104:107], v[144:147], 0
    v_mfma_f32_16x16x32_bf16 v[52:55], v[104:107], v[148:151], 0
    v_mfma_f32_16x16x32_bf16 v[40:43], v[104:107], v[136:139], 0
    v_mfma_f32_16x16x32_bf16 v[60:63], v[120:123], v[140:143], 0
    v_mfma_f32_16x16x32_bf16 v[64:67], v[120:123], v[144:147], 0
    v_mfma_f32_16x16x32_bf16 v[68:71], v[120:123], v[148:151], 0
    v_mfma_f32_16x16x32_bf16 v[56:59], v[120:123], v[136:139], 0
    s_waitcnt vmcnt(8)
L_Ak1:
    v_max3_u32 v1, v152, v156, v160
    v_max_u32 v1, v1, v164
    v_cmp_eq_u32 vcc, -1, v1
    s_cbranch_vccnz L_Ak1r
L_Ak1d:
    v_cndmask_b32 v152, v152, v154, s[48:49]
    v_cndmask_b32 v153, v153, v155, s[48:49]
    v_cndmask_b32 v154, v154, 0, s[50:51]
    v_cndmask_b32 v155, v155, 0, s[50:51]
    v_mfma_f32_16x16x32_bf16 v[12:15], v[76:79], v[156:159], v[12:15]
    v_mfma_f32_16x16x32_bf16 v[16:19], v[76:79], v[160:163], v[16:19]
    v_mfma_f32_16x16x32_bf16 v[20:23], v[76:79], v[164:167], v[20:23]
    v_mfma_f32_16x16x32_bf16 v[8:11], v[76:79], v[152:155], v[8:11]
    v_mfma_f32_16x16x32_bf16 v[28:31], v[92:95], v[156:159], v[28:31]
    v_mfma_f32_16x16x32_bf16 v[32:35], v[92:95], v[160:163], v[32:35]
    v_mfma_f32_16x16x32_bf16 v[36:39], v[92:95], v[164:167], v[36:39]
    v_mfma_f32_16x16x32_bf16 v[24:27], v[92:95], v[152:155], v[24:27]
    v_mfma_f32_16x16x32_bf16 v[44:47], v[108:111], v[156:159], v[44:47]
    v_mfma_f32_16x16x32_bf16 v[48:51], v[108:111], v[160:163], v[48:51]
    v_mfma_f32_16x16x32_bf16 v[52:55], v[108:111], v[164:167], v[52:55]
    v_mfma_f32_16x16x32_bf16 v[40:43], v[108:111], v[152:155], v[40:43]
    v_mfma_f32_16x16x32_bf16 v[60:63], v[124:127], v[156:159], v[60:63]
    v_mfma_f32_16x16x32_bf16 v[64:67], v[124:127], v[160:163], v[64:67]
    v_mfma_f32_16x16x32_bf16 v[68:71], v[124:127], v[164:167], v[68:71]
    v_mfma_f32_16x16x32_bf16 v[56:59], v[124:127], v[152:155], v[56:59]
    s_waitcnt vmcnt(4)
L_Ak2:
    v_max3_u32 v1, v168, v172, v176
    v_max_u32 v1, v1, v180
    v_cmp_eq_u32 vcc, -1, v1
    s_cbranch_vccnz L_Ak2r
L_Ak2d:
    v_cndmask_b32 v168, v168, v170, s[48:49]
    v_cndmask_b32 v169, v169, v171, s[48:49]
    v_cndmask_b32 v170, v170, 0, s[50:51]
    v_cndmask_b32 v171, v171, 0, s[50:51]
    v_mfma_f32_16x16x32_bf16 v[12:15], v[80:83], v[172:175], v[12:15]
    v_mfma_f32_16x16x32_bf16 v[16:19], v[80:83], v[176:179], v[16:19]
    v_mfma_f32_16x16x32_bf16 v[20:23], v[80:83], v[180:183], v[20:23]
    v_mfma_f32_16x16x32_bf16 v[8:11], v[80:83], v[168:171], v[8:11]
    v_mfma_f32_16x16x32_bf16 v[28:31], v[96:99], v[172:175], v[28:31]
    v_mfma_f32_16x16x32_bf16 v[32:35], v[96:99], v[176:179], v[32:35]
    v_mfma_f32_16x16x32_bf16 v[36:39], v[96:99], v[180:183], v[36:39]
    v_mfma_f32_16x16x32_bf16 v[24:27], v[96:99], v[168:171], v[24:27]
    v_mfma_f32_16x16x32_bf16 v[44:47], v[112:115], v[172:175], v[44:47]
    v_mfma_f32_16x16x32_bf16 v[48:51], v[112:115], v[176:179], v[48:51]
    v_mfma_f32_16x16x32_bf16 v[52:55], v[112:115], v[180:183], v[52:55]
    v_mfma_f32_16x16x32_bf16 v[40:43], v[112:115], v[168:171], v[40:43]
    v_mfma_f32_16x16x32_bf16 v[60:63], v[128:131], v[172:175], v[60:63]
    v_mfma_f32_16x16x32_bf16 v[64:67], v[128:131], v[176:179], v[64:67]
    v_mfma_f32_16x16x32_bf16 v[68:71], v[128:131], v[180:183], v[68:71]
    v_mfma_f32_16x16x32_bf16 v[56:59], v[128:131], v[168:171], v[56:59]
    s_waitcnt vmcnt(0)
L_Ak3:
    v_max3_u32 v1, v184, v188, v192
    v_max_u32 v1, v1, v196
    v_cmp_eq_u32 vcc, -1, v1
    s_cbranch_vccnz L_Ak3r
L_Ak3d:
    v_cndmask_b32 v184, v184, v186, s[48:49]
    v_cndmask_b32 v185, v185, v187, s[48:49]
    v_cndmask_b32 v186, v186, 0, s[50:51]
    v_cndmask_b32 v187, v187, 0, s[50:51]
    v_mfma_f32_16x16x32_bf16 v[12:15], v[84:87], v[188:191], v[12:15]
    v_mfma_f32_16x16x32_bf16 v[16:19], v[84:87], v[192:195], v[16:19]
    v_mfma_f32_16x16x32_bf16 v[20:23], v[84:87], v[196:199], v[20:23]
    v_mfma_f32_16x16x32_bf16 v[8:11], v[84:87], v[184:187], v[8:11]
    v_mfma_f32_16x16x32_bf16 v[28:31], v[100:103], v[188:191], v[28:31]
    v_mfma_f32_16x16x32_bf16 v[32:35], v[100:103], v[192:195], v[32:35]
    v_mfma_f32_16x16x32_bf16 v[36:39], v[100:103], v[196:199], v[36:39]
    v_mfma_f32_16x16x32_bf16 v[24:27], v[100:103], v[184:187], v[24:27]
    v_mfma_f32_16x16x32_bf16 v[44:47], v[116:119], v[188:191], v[44:47]
    v_mfma_f32_16x16x32_bf16 v[48:51], v[116:119], v[192:195], v[48:51]
    v_mfma_f32_16x16x32_bf16 v[52:55], v[116:119], v[196:199], v[52:55]
    v_mfma_f32_16x16x32_bf16 v[40:43], v[116:119], v[184:187], v[40:43]
    v_mfma_f32_16x16x32_bf16 v[60:63], v[132:135], v[188:191], v[60:63]
    v_mfma_f32_16x16x32_bf16 v[64:67], v[132:135], v[192:195], v[64:67]
    v_mfma_f32_16x16x32_bf16 v[68:71], v[132:135], v[196:199], v[68:71]
    v_mfma_f32_16x16x32_bf16 v[56:59], v[132:135], v[184:187], v[56:59]
    v_cvt_pk_bf16_f32 v136, v8, v12
    v_cvt_pk_bf16_f32 v137, v16, v20
    buffer_store_dwordx2 v[136:137], v216, s[20:23], 0 offen sc0 sc1
    v_cvt_pk_bf16_f32 v138, v9, v13
    v_cvt_pk_bf16_f32 v139, v17, v21
    buffer_store_dwordx2 v[138:139], v217, s[20:23], 0 offen sc0 sc1
    v_cvt_pk_bf16_f32 v140, v10, v14
    v_cvt_pk_bf16_f32 v141, v18, v22
    buffer_store_dwordx2 v[140:141], v218, s[20:23], 0 offen sc0 sc1
    v_cvt_pk_bf16_f32 v142, v11, v15
    v_cvt_pk_bf16_f32 v143, v19, v23
    buffer_store_dwordx2 v[142:143], v219, s[20:23], 0 offen sc0 sc1
    v_cvt_pk_bf16_f32 v144, v24, v28
    v_cvt_pk_bf16_f32 v145, v32, v36
    buffer_store_dwordx2 v[144:145], v220, s[20:23], 0 offen sc0 sc1
    v_cvt_pk_bf16_f32 v146, v25, v29
    v_cvt_pk_bf16_f32 v147, v33, v37
    buffer_store_dwordx2 v[146:147], v221, s[20:23], 0 offen sc0 sc1
    v_cvt_pk_bf16_f32 v148, v26, v30
    v_cvt_pk_bf16_f32 v149, v34, v38
    buffer_store_dwordx2 v[148:149], v222, s[20:23], 0 offen sc0 sc1
    v_cvt_pk_bf16_f32 v150, v27, v31
    v_cvt_pk_bf16_f32 v151, v35, v39
    buffer_store_dwordx2 v[150:151], v223, s[20:23], 0 offen sc0 sc1
    v_cvt_pk_bf16_f32 v152, v40, v44
    v_cvt_pk_bf16_f32 v153, v48, v52
    buffer_store_dwordx2 v[152:153], v224, s[20:23], 0 offen sc0 sc1
    v_cvt_pk_bf16_f32 v154, v41, v45
    v_cvt_pk_bf16_f32 v155, v49, v53
    buffer_store_dwordx2 v[154:155], v225, s[20:23], 0 offen sc0 sc1
    v_cvt_pk_bf16_f32 v156, v42, v46
    v_cvt_pk_bf16_f32 v157, v50, v54
    buffer_store_dwordx2 v[156:157], v226, s[20:23], 0 offen sc0 sc1
    v_cvt_pk_bf16_f32 v158, v43, v47
    v_cvt_pk_bf16_f32 v159, v51, v55
    buffer_store_dwordx2 v[158:159], v227, s[20:23], 0 offen sc0 sc1
    v_cvt_pk_bf16_f32 v160, v56, v60
    v_cvt_pk_bf16_f32 v161, v64, v68
    buffer_store_dwordx2 v[160:161], v228, s[20:23], 0 offen sc0 sc1
    v_cvt_pk_bf16_f32 v162, v57, v61
    v_cvt_pk_bf16_f32 v163, v65, v69
    buffer_store_dwordx2 v[162:163], v229, s[20:23], 0 offen sc0 sc1
    v_cvt_pk_bf16_f32 v164, v58, v62
    v_cvt_pk_bf16_f32 v165, v66, v70
    buffer_store_dwordx2 v[164:165], v230, s[20:23], 0 offen sc0 sc1
    v_cvt_pk_bf16_f32 v166, v59, v63
    v_cvt_pk_bf16_f32 v167, v67, v71
    buffer_store_dwordx2 v[166:167], v231, s[20:23], 0 offen sc0 sc1
    s_endpgm
L_Ak0r:
    s_sub_u32 s5, s5, 1
    s_cmp_lt_i32 s5, 0
    s_cbranch_scc1 L_Ak0d
    buffer_load_dwordx4 v[136:139], v232, s[24:27], s56 offen sc1
    buffer_load_dwordx4 v[140:143], v233, s[24:27], s56 offen sc1
    buffer_load_dwordx4 v[144:147], v234, s[24:27], s56 offen sc1
    buffer_load_dwordx4 v[148:151], v235, s[24:27], s56 offen sc1
    buffer_load_dwordx4 v[152:155], v232, s[24:27], s57 offen sc1
    buffer_load_dwordx4 v[156:159], v233, s[24:27], s57 offen sc1
    buffer_load_dwordx4 v[160:163], v234, s[24:27], s57 offen sc1
    buffer_load_dwordx4 v[164:167], v235, s[24:27], s57 offen sc1
    buffer_load_dwordx4 v[168:171], v232, s[24:27], s58 offen sc1
    buffer_load_dwordx4 v[172:175], v233, s[24:27], s58 offen sc1
    buffer_load_dwordx4 v[176:179], v234, s[24:27], s58 offen sc1
    buffer_load_dwordx4 v[180:183], v235, s[24:27], s58 offen sc1
    buffer_load_dwordx4 v[184:187], v232, s[24:27], s59 offen sc1
    buffer_load_dwordx4 v[188:191], v233, s[24:27], s59 offen sc1
    buffer_load_dwordx4 v[192:195], v234, s[24:27], s59 offen sc1
    buffer_load_dwordx4 v[196:199], v235, s[24:27], s59 offen sc1
    s_waitcnt vmcnt(12)
    s_branch L_Ak0
L_Ak1r:
    s_sub_u32 s5, s5, 1
    s_cmp_lt_i32 s5, 0
    s_cbranch_scc1 L_Ak1d
    buffer_load_dwordx4 v[152:155], v232, s[24:27], s57 offen sc1
    buffer_load_dwordx4 v[156:159], v233, s[24:27], s57 offen sc1
    buffer_load_dwordx4 v[160:163], v234, s[24:27], s57 offen sc1
    buffer_load_dwordx4 v[164:167], v235, s[24:27], s57 offen sc1
    buffer_load_dwordx4 v[168:171], v232, s[24:27], s58 offen sc1
    buffer_load_dwordx4 v[172:175], v233, s[24:27], s58 offen sc1
    buffer_load_dwordx4 v[176:179], v234, s[24:27], s58 offen sc1
    buffer_load_dwordx4 v[180:183], v235, s[24:27], s58 offen sc1
    buffer_load_dwordx4 v[184:187], v232, s[24:27], s59 offen sc1
    buffer_load_dwordx4 v[188:191], v233, s[24:27], s59 offen sc1
    buffer_load_dwordx4 v[192:195], v234, s[24:27], s59 offen sc1
    buffer_load_dwordx4 v[196:199], v235, s[24:27], s59 offen sc1
    s_waitcnt vmcnt(8)
    s_branch L_Ak1
L_Ak2r:
    s_sub_u32 s5, s5, 1
    s_cmp_lt_i32 s5, 0
    s_cbranch_scc1 L_Ak2d
    buffer_load_dwordx4 v[168:171], v232, s[24:27], s58 offen sc1
    buffer_load_dwordx4 v[172:175], v233, s[24:27], s58 offen sc1
    buffer_load_dwordx4 v[176:179], v234, s[24:27], s58 offen sc1
    buffer_load_dwordx4 v[180:183], v235, s[24:27], s58 offen sc1
    buffer_load_dwordx4 v[184:187], v232, s[24:27], s59 offen sc1
    buffer_load_dwordx4 v[188:191], v233, s[24:27], s59 offen sc1
    buffer_load_dwordx4 v[192:195], v234, s[24:27], s59 offen sc1
    buffer_load_dwordx4 v[196:199], v235, s[24:27], s59 offen sc1
    s_waitcnt vmcnt(4)
    s_branch L_Ak2
L_Ak3r:
    s_sub_u32 s5, s5, 1
    s_cmp_lt_i32 s5, 0
    s_cbranch_scc1 L_Ak3d
    buffer_load_dwordx4 v[184:187], v232, s[24:27], s59 offen sc1
    buffer_load_dwordx4 v[188:191], v233, s[24:27], s59 offen sc1
    buffer_load_dwordx4 v[192:195], v234, s[24:27], s59 offen sc1
    buffer_load_dwordx4 v[196:199], v235, s[24:27], s59 offen sc1
    s_waitcnt vmcnt(0)
    s_branch L_Ak3
L_end:
L_last:
    s_endpgm
.section .rodata,"a"
.p2align 6
.amdhsa_kernel concat_heads__spectral_fnet__sliding_local_dilated__prompt_kernel
  .amdhsa_next_free_vgpr 256
  .amdhsa_next_free_sgpr 102
  .amdhsa_accum_offset 256
  .amdhsa_group_segment_fixed_size 0
  .amdhsa_kernarg_size 88
  .amdhsa_user_sgpr_count 2
  .amdhsa_user_sgpr_kernarg_segment_ptr 1
  .amdhsa_system_sgpr_workgroup_id_x 1
.end_amdhsa_kernel
```
